```python
import torch

def _softmax(x, axis=-1):
    return torch.softmax(x, dim=axis)
def _gelu(x):
    return torch.nn.functional.gelu(x, approximate="tanh")
def _silu(x):
    return torch.nn.functional.silu(x)
def _sigmoid(x):
    return torch.sigmoid(x)
def _layernorm(x, axis=-1, eps=1e-5):
    m = x.mean(dim=axis, keepdim=True)
    v = x.var(dim=axis, keepdim=True, unbiased=False)
    return (x - m) / torch.sqrt(v + eps)
def _scatter_add(tgt, idx, src, axis=0):
    return tgt.clone().index_add_(axis, idx, src)
def _segment_sum(src, seg, n):
    out = torch.zeros((n,) + src.shape[1:], dtype=src.dtype)
    return out.index_add_(0, seg, src)
def _pad(x, pw):
    flat = tuple(v for pair in reversed(pw) for v in pair)
    return torch.nn.functional.pad(x, flat)

kernel_name = 'gated_mix__sliding_block_cached__glu_gated_reglu__decode'

def setup_inputs():

    _w = (lambda a: (lambda t: t.to(torch.bfloat16) if t.is_floating_point() else t)(torch.as_tensor(a)))
    def _A_setup():
        B, Sq, D = 1, 1, 576
        Hq, Hkv, Sk, Dh = 32, 16, 65536, 128
        assert Hq % Hkv == 0, (Hq, Hkv)
        return {
            "x": _w((lambda *s: torch.randn(*s, dtype=torch.bfloat16) * 0.05)(B, Sq, D)),
            "k_cache": _w((lambda *s: torch.randn(*s, dtype=torch.bfloat16) * 3.2)(B, Hkv, Sk, Dh)),
            "v_cache": _w((lambda *s: torch.randn(*s, dtype=torch.bfloat16) * 0.05)(B, Hkv, Sk, Dh)),
            "wq": _w((lambda *s: torch.randn(*s, dtype=torch.bfloat16) * 3.2)(D, Hq * Dh) * (D ** -0.5)),
            "wo": _w((lambda *s: torch.randn(*s, dtype=torch.bfloat16) * 0.05)(Hq * Dh, D) * ((Hq * Dh) ** -0.5)),
        }
    _A_in = _A_setup()

    def _B_setup():
        B, S, D, F = 1, 1, 576, 4608
        return {
            "x": _w((lambda *s: torch.randn(*s, dtype=torch.bfloat16) * 0.05)(B, S, D)),
            "W_gate": _w((lambda *s: torch.randn(*s, dtype=torch.bfloat16) * 0.2)(D, F) * (2.0 / D) ** 0.5),
            "W_up": _w((lambda *s: torch.randn(*s, dtype=torch.bfloat16) * 0.2)(D, F) * (2.0 / D) ** 0.5),
            "W_down": _w((lambda *s: torch.randn(*s, dtype=torch.bfloat16) * 0.2)(F, D) * (1.0 / F) ** 0.5),
        }
    _B_in = _B_setup()

    return {
        "A_x": _A_in["x"],
        "A_k_cache": _A_in["k_cache"],
        "A_v_cache": _A_in["v_cache"],
        "A_wq": _A_in["wq"],
        "A_wo": _A_in["wo"],
        "B_x": _B_in["x"],
        "B_W_gate": _B_in["W_gate"],
        "B_W_up": _B_in["W_up"],
        "B_W_down": _B_in["W_down"],
        "gate_w": _w((lambda *s: torch.randn(*s, dtype=torch.bfloat16) * 0.05)(576) * 16.0),
    }

def reference(A_x, A_k_cache, A_v_cache, A_wq, A_wo, B_x, B_W_gate, B_W_up, B_W_down, gate_w):
    def _A_ref(x, k_cache, v_cache, wq, wo):
        B, Sq, D = x.shape
        Hq, Dh = 32, 128
        Hkv, Sk = k_cache.shape[1], k_cache.shape[2]
        W = min(4096, max(256, Sk // 4))
        rep = Hq // Hkv
        q = (lambda x, *d: x.permute(*d))((x @ wq).reshape(B, Sq, Hq, Dh), 0, 2, 1, 3)
        k = (lambda x, n, axis: torch.repeat_interleave(x, n, dim=axis))(k_cache[:, :, Sk - W:, :], rep, axis=1)
        v = (lambda x, n, axis: torch.repeat_interleave(x, n, dim=axis))(v_cache[:, :, Sk - W:, :], rep, axis=1)
        scores = torch.einsum("bhqd,bhkd->bhqk", q, k) * (Dh ** -0.5)
        p = _softmax(scores, axis=-1)
        o = torch.einsum("bhqk,bhkd->bhqd", p, v)
        return (lambda x, *d: x.permute(*d))(o, 0, 2, 1, 3).reshape(B, Sq, Hq * Dh) @ wo

    def _B_ref(x, W_gate, W_up, W_down):
        gate = torch.einsum("bsd,df->bsf", x, W_gate)
        up = torch.einsum("bsd,df->bsf", x, W_up)
        gate = gate * (lambda x, dt: x.to(dt))(gate > 0, gate.dtype)
        h = gate * up
        return torch.einsum("bsf,fd->bsd", h, W_down)

    x = A_x
    g = _sigmoid((x * gate_w).sum(-1, keepdims=True))
    a = _A_ref(x, A_k_cache, A_v_cache, A_wq, A_wo)
    b = _B_ref(x, B_W_gate, B_W_up, B_W_down)
    return g * a + (1 - g) * b
```

```asm
; @launch grid=(256,1,1) block=(768,1,1) lds=90112
.amdgcn_target "amdgcn-amd-amdhsa--gfx950"
.text
.globl gated_mix__sliding_block_cached__glu_gated_reglu__decode_kernel
.p2align 8
.type gated_mix__sliding_block_cached__glu_gated_reglu__decode_kernel,@function
gated_mix__sliding_block_cached__glu_gated_reglu__decode_kernel:
s_cmp_ge_u32 s2, 256
s_cbranch_scc1 L_end
s_load_dwordx16 s[4:19], s[0:1], 0
s_load_dwordx8 s[20:27], s[0:1], 64
s_load_dwordx2 s[28:29], s[0:1], 96
v_lshrrev_b32 v5, 6, v0
v_and_b32 v1, 63, v0
v_readfirstlane_b32 s3, v5
s_setprio 3
s_and_b32 s96, s2, 7
s_lshr_b32 s97, s2, 3
s_and_b32 s98, s97, 1
s_lshl_b32 s98, s98, 3
s_add_u32 s98, s98, s96
s_lshr_b32 s99, s97, 1
v_lshrrev_b32 v6, 4, v1
v_bfe_u32 v152, v1, 3, 1
v_lshlrev_b32 v4, 4, v1
v_lshl_add_u32 v153, v152, 2, v6
s_cmp_eq_u32 s3, 0
s_cbranch_scc1 L_swave
v_and_b32 v154, 7, v1
v_lshlrev_b32 v154, 4, v154
s_cmp_ge_u32 s3, 10
s_cbranch_scc1 L_ewave
s_sub_u32 s3, s3, 2
s_min_u32 s3, s3, 8
v_lshl_add_u32 v158, v153, 14, v154
s_mul_i32 s64, s2, 1171
s_lshr_b32 s64, s64, 16
s_mul_i32 s65, s64, 56
s_sub_u32 s65, s2, s65
s_mul_i32 s91, s65, 37
s_lshr_b32 s91, s91, 8
s_add_u32 s91, s91, s65
s_and_b32 s65, s91, 7
s_cmp_ge_u32 s65, 3
s_addc_u32 s91, s91, 0
s_lshl_b32 s65, s96, 3
s_add_u32 s65, s65, 3
s_sub_u32 s31, s97, 28
s_cmp_ge_u32 s97, 28
s_cselect_b32 s91, s65, s91
s_cselect_b32 s64, s31, s64
s_mul_i32 s90, s64, 144
s_lshl_b32 s65, s3, 4
s_add_u32 s90, s90, s65
s_lshl_b32 s67, s90, 13
s_lshl_b32 s65, s91, 7
s_add_u32 s67, s67, s65
s_add_u32 s65, s67, 0x2000
s_mov_b32 s54, 4718592
s_mov_b32 s55, 0x20000
s_mov_b32 s42, 5308416
s_mov_b32 s43, 0x20000
s_mov_b32 s58, 5308416
s_mov_b32 s59, 0x20000
s_waitcnt lgkmcnt(0)
s_mov_b64 s[52:53], s[10:11]
buffer_load_dwordx4 v[28:31], v158, s[52:55], s67 offen nt
buffer_load_dwordx4 v[32:35], v158, s[52:55], s65 offen nt
s_mul_i32 s30, s97, 22
s_lshr_b32 s30, s30, 6
s_mul_i32 s92, s30, 3
s_sub_u32 s92, s97, s92
s_cmp_lt_u32 s97, 27
s_cbranch_scc1 L_gm1
s_sub_u32 s30, 3, s96
s_and_b32 s30, s30, 7
s_sub_u32 s92, s97, 24
s_cmp_lt_u32 s97, 29
s_cbranch_scc1 L_gm1
s_mov_b32 s30, 8
s_sub_u32 s92, 33, s97
L_gm1:
s_mul_i32 s64, s96, 9
s_add_u32 s30, s30, s64
s_and_b32 s64, s30, 7
s_cmp_eq_u32 s64, 3
s_cselect_b32 s95, 1, 0
s_cmp_lt_u32 s97, 29
s_cbranch_scc1 L_gn1
s_cmp_eq_u32 s97, 31
s_cselect_b32 s95, 0, s95
s_cmp_eq_u32 s95, 0
s_cselect_b32 s95, 2, s95
L_gn1:
s_and_b32 s31, s95, 1
s_sub_u32 s31, 3, s31
s_lshl_b32 s64, s92, 3
s_add_u32 s64, s64, s3
s_mul_i32 s93, s64, s31
s_lshl_b32 s93, s93, 3
s_mul_i32 s66, s93, 0x2400
s_lshl_b32 s64, s30, 7
s_add_u32 s66, s66, s64
s_mul_i32 s64, s31, 0x2400
v_mad_u32_u24 v2, v153, s64, v154
s_lshl_b32 s31, s31, 1
v_mul_u32_u24 v12, s31, v153
s_setprio 0
s_mov_b64 s[40:41], s[16:17]
s_mov_b64 s[56:57], s[18:19]
s_cmp_eq_u32 s3, 8
s_cbranch_scc1 L_l1k
s_cmp_eq_u32 s95, 2
s_cbranch_scc1 L_l1k
buffer_load_dwordx4 v[40:43], v2, s[40:43], s66 offen nt
buffer_load_dwordx4 v[52:55], v2, s[56:59], s66 offen nt
s_add_u32 s66, s66, 0x2400
buffer_load_dwordx4 v[44:47], v2, s[40:43], s66 offen nt
buffer_load_dwordx4 v[56:59], v2, s[56:59], s66 offen nt
s_add_u32 s66, s66, 0x2400
L_l1k:
s_lshl_b32 s64, s98, 24
s_lshl_b32 s65, s99, 16
s_add_u32 s64, s64, s65
s_add_u32 s64, s64, 15728640
s_lshl_b32 s68, s3, 13
s_add_u32 s69, s68, 4096
s_add_u32 s32, s6, s64
s_addc_u32 s33, s7, 0
s_mov_b32 s34, 0x10000
s_mov_b32 s35, 0x20000
s_add_u32 s36, s8, s64
s_addc_u32 s37, s9, 0
s_mov_b32 s38, 0x10000
s_mov_b32 s39, 0x20000
v_and_b32 v156, 15, v1
v_lshlrev_b32 v148, 2, v6
v_xor_b32 v148, v148, v156
v_lshlrev_b32 v148, 4, v148
v_lshl_add_u32 v148, v6, 8, v148
v_xor_b32 v149, 16, v148
v_xor_b32 v150, 32, v148
v_xor_b32 v151, 48, v148
s_cmp_lg_u32 s95, 2
s_cbranch_scc1 L_l1e
s_cmp_eq_u32 s3, 8
s_cbranch_scc1 L_l1e
s_mov_b32 m0, s68
s_nop 0
buffer_load_dwordx4 v148, s[32:35], s68 offen offset:0 nt lds
buffer_load_dwordx4 v149, s[32:35], s68 offen offset:1024 nt lds
buffer_load_dwordx4 v150, s[32:35], s68 offen offset:2048 nt lds
buffer_load_dwordx4 v151, s[32:35], s68 offen offset:3072 nt lds
L_l1e:
v_and_b32 v155, 3, v1
v_bfe_u32 v157, v1, 2, 2
v_lshl_add_u32 v155, v155, 2, v157
v_xor_b32 v156, v156, v6
v_lshlrev_b32 v156, 4, v156
v_lshl_add_u32 v3, v155, 8, v156
v_add_u32 v3, s68, v3
s_load_dword s60, s[28:29], 0
v_and_b32 v155, 1, v1
v_lshlrev_b32 v155, 4, v155
v_mov_b32 v156, 0xffff
v_lshlrev_b32 v155, v155, v156
v_bfe_u32 v156, v1, 1, 2
v_cmp_eq_u32 vcc, 0, v156
s_nop 1
v_cndmask_b32 v8, 0, v155, vcc
v_cmp_eq_u32 vcc, 1, v156
s_nop 1
v_cndmask_b32 v9, 0, v155, vcc
v_cmp_eq_u32 vcc, 2, v156
s_nop 1
v_cndmask_b32 v10, 0, v155, vcc
v_cmp_eq_u32 vcc, 3, v156
s_nop 1
v_cndmask_b32 v11, 0, v155, vcc
v_mov_b32 v7, 0x3ff
s_mov_b32 s44, s12
s_mov_b32 s45, s13
s_mov_b32 s46, 4718592
s_mov_b32 s47, 0x20000
s_mov_b32 s48, s20
s_mov_b32 s49, s21
s_mov_b32 s50, 5308416
s_mov_b32 s51, 0x20000
v_lshlrev_b32 v155, 1, v154
v_lshl_add_u32 v155, v152, 8, v155
v_and_b32 v156, 1, v6
v_lshl_add_u32 v155, v156, 4, v155
s_lshl_b32 s64, s3, 9
s_add_u32 s64, s64, 65536
v_add_u32 v156, s64, v155
s_lshl_b32 s64, s90, 1
s_add_u32 s64, s64, 79360
v_lshl_add_u32 v5, v153, 2, s64
s_lshl_b32 s64, s93, 1
s_add_u32 s64, s64, 79360
v_add_u32 v12, s64, v12
s_waitcnt lgkmcnt(0)
s_mov_b32 s101, 0xfffffc00
s_add_u32 s94, s60, 1
s_and_b32 s60, s94, 0x3ff
s_add_u32 s61, s94, 341
s_and_b32 s61, s61, 0x3ff
s_add_u32 s62, s94, 682
s_and_b32 s62, s62, 0x3ff
s_add_u32 s63, s94, 1023
s_and_b32 s63, s63, 0x3ff
s_cmp_eq_u32 s3, 8
s_cbranch_scc1 L_i2d
s_cmp_eq_u32 s95, 0
s_cbranch_scc0 L_i2k
buffer_load_dwordx4 v[48:51], v2, s[40:43], s66 offen nt
buffer_load_dwordx4 v[60:63], v2, s[56:59], s66 offen nt
s_waitcnt vmcnt(6)
s_branch L_i2d
L_i2k:
s_waitcnt vmcnt(4)
L_i2d:
s_barrier
ds_read_b32 v5, v5
ds_read_u16 v13, v12 offset:2
ds_read_u16 v14, v12 offset:4
ds_read_u16 v12, v12
s_mov_b32 s64, 0x01000100
s_mov_b32 s65, 0x03020302
s_cmp_lg_u32 s3, 8
s_cbranch_scc1 L_nocw
s_waitcnt vmcnt(0)
L_nocw:
s_waitcnt lgkmcnt(3)
v_perm_b32 v158, v5, v5, s64
v_perm_b32 v159, v5, v5, s65
v_and_b32 v16, v158, v8
v_and_b32 v17, v158, v9
v_and_b32 v18, v158, v10
v_and_b32 v19, v158, v11
v_and_b32 v20, v159, v8
v_and_b32 v21, v159, v9
v_and_b32 v22, v159, v10
v_and_b32 v23, v159, v11
s_nop 0
v_mfma_f32_16x16x32_bf16 v[36:39], v[16:19], v[28:31], 0
v_mfma_f32_16x16x32_bf16 v[36:39], v[20:23], v[32:35], v[36:39]
s_mov_b32 exec_lo, 0xff00ff
s_mov_b32 exec_hi, 0xff00ff00
s_nop 5
ds_write_b128 v156, v[36:39]
s_mov_b64 exec, -1
s_waitcnt lgkmcnt(0)
s_barrier
s_barrier
s_cmp_eq_u32 s3, 8
s_cbranch_scc1 L_cwave
s_cmp_eq_u32 s95, 2
s_cbranch_scc1 L_nop1
v_perm_b32 v158, v12, v12, s64
v_and_b32 v16, v158, v8
v_and_b32 v17, v158, v9
v_and_b32 v18, v158, v10
v_and_b32 v19, v158, v11
v_perm_b32 v158, v13, v13, s64
v_and_b32 v20, v158, v8
v_and_b32 v21, v158, v9
v_and_b32 v22, v158, v10
v_and_b32 v23, v158, v11
v_perm_b32 v158, v14, v14, s64
v_and_b32 v68, v158, v8
v_and_b32 v69, v158, v9
v_and_b32 v70, v158, v10
v_and_b32 v71, v158, v11
s_mov_b32 m0, s68
s_nop 0
buffer_load_dwordx4 v148, s[32:35], s68 offen offset:0 nt lds
buffer_load_dwordx4 v149, s[32:35], s68 offen offset:1024 nt lds
s_waitcnt vmcnt(7)
buffer_load_dwordx4 v150, s[32:35], s68 offen offset:2048 nt lds
s_waitcnt vmcnt(7)
buffer_load_dwordx4 v151, s[32:35], s68 offen offset:3072 nt lds
s_waitcnt vmcnt(7)
s_mov_b32 m0, s69
s_nop 0
buffer_load_dwordx4 v148, s[32:35], s69 offen offset:0 nt lds
s_waitcnt vmcnt(7)
buffer_load_dwordx4 v149, s[32:35], s69 offen offset:1024 nt lds
s_waitcnt vmcnt(7)
buffer_load_dwordx4 v150, s[32:35], s69 offen offset:2048 nt lds
s_waitcnt vmcnt(7)
v_mfma_f32_16x16x32_bf16 v[24:27], v[16:19], v[40:43], 0
v_mfma_f32_16x16x32_bf16 v[64:67], v[16:19], v[52:55], 0
v_mfma_f32_16x16x32_bf16 v[24:27], v[20:23], v[44:47], v[24:27]
v_mfma_f32_16x16x32_bf16 v[64:67], v[20:23], v[56:59], v[64:67]
s_cmp_eq_u32 s95, 1
s_cbranch_scc1 L_m3
v_mfma_f32_16x16x32_bf16 v[24:27], v[68:71], v[48:51], v[24:27]
v_mfma_f32_16x16x32_bf16 v[64:67], v[68:71], v[60:63], v[64:67]
L_m3:
s_mov_b32 exec_lo, 0xff00ff
s_mov_b32 exec_hi, 0xff00ff00
s_nop 4
ds_write_b128 v156, v[24:27] offset:4608
ds_write_b128 v156, v[64:67] offset:8704
s_mov_b64 exec, -1
s_waitcnt lgkmcnt(0)
s_barrier
s_barrier
s_waitcnt vmcnt(7)
buffer_load_dwordx4 v151, s[32:35], s69 offen offset:3072 nt lds
s_branch L_av
L_nop1:
s_mov_b32 m0, s69
s_nop 0
buffer_load_dwordx4 v148, s[32:35], s69 offen offset:0 nt lds
buffer_load_dwordx4 v149, s[32:35], s69 offen offset:1024 nt lds
buffer_load_dwordx4 v150, s[32:35], s69 offen offset:2048 nt lds
buffer_load_dwordx4 v151, s[32:35], s69 offen offset:3072 nt lds
L_av:
v_subrev_u32 v14, 65536, v156
s_mul_i32 s31, s97, 29
s_lshr_b32 s31, s31, 8
s_mul_i32 s65, s31, 9
s_sub_u32 s93, s97, s65
s_add_u32 s30, s93, s96
s_sub_u32 s65, s30, 9
s_cmp_ge_u32 s30, 9
s_cselect_b32 s30, s65, s30
v_lshl_add_u32 v153, v6, 1, v152
s_movk_i32 s64, 2304
v_mad_u32_u24 v2, v153, s64, v154
s_lshl_b32 s64, s3, 6
s_add_u32 s64, s64, 70144
v_lshl_add_u32 v13, v153, 3, s64
s_mul_i32 s93, s3, 18432
s_lshl_b32 s64, s30, 7
s_add_u32 s93, s93, s64
s_lshr_b32 s64, s31, 1
s_lshl_b32 s64, s64, 3
s_add_u32 s66, s64, s96
s_and_b32 s67, s31, 1
s_lshl_b32 s64, s66, 1
s_add_u32 s64, s64, s67
s_mul_i32 s64, s64, 147456
s_add_u32 s30, s64, s93
v_mov_b32 v155, 78336
v_lshl_add_u32 v155, v152, 8, v155
v_lshl_add_u32 v155, v6, 4, v155
v_xor_b32 v160, 64, v3
v_xor_b32 v161, 128, v3
v_xor_b32 v162, 192, v3
s_waitcnt vmcnt(7)
buffer_load_dwordx4 v[104:107], v4, s[36:39], s68 offen offset:0 nt
s_waitcnt vmcnt(7)
buffer_load_dwordx4 v[108:111], v4, s[36:39], s68 offen offset:1024 nt
s_waitcnt vmcnt(7)
buffer_load_dwordx4 v[112:115], v4, s[36:39], s68 offen offset:2048 nt
s_waitcnt vmcnt(7)
buffer_load_dwordx4 v[116:119], v4, s[36:39], s68 offen offset:3072 nt
s_waitcnt vmcnt(7)
buffer_load_dwordx4 v[120:123], v4, s[36:39], s69 offen offset:0 nt
s_waitcnt vmcnt(7)
buffer_load_dwordx4 v[124:127], v4, s[36:39], s69 offen offset:1024 nt
s_waitcnt vmcnt(7)
buffer_load_dwordx4 v[128:131], v4, s[36:39], s69 offen offset:2048 nt
s_waitcnt vmcnt(7)
buffer_load_dwordx4 v[132:135], v4, s[36:39], s69 offen offset:3072 nt
s_barrier
ds_read_b128 v[136:139], v155 offset:0
ds_read_b128 v[140:143], v155 offset:64
ds_read_b128 v[144:147], v155 offset:128
ds_read_b128 v[148:151], v155 offset:192
ds_read_b128 v[72:75], v3 offset:0
ds_read_b128 v[88:91], v3 offset:4096
ds_read_b128 v[76:79], v160 offset:0
ds_read_b128 v[92:95], v160 offset:4096
ds_read_b128 v[80:83], v161 offset:0
ds_read_b128 v[96:99], v161 offset:4096
ds_read_b128 v[84:87], v162 offset:0
ds_read_b128 v[100:103], v162 offset:4096
v_mov_b32 v155, 79040
v_lshl_add_u32 v155, v152, 5, v155
s_lshl_b32 s64, s3, 2
v_add_u32 v159, s64, v155
s_waitcnt lgkmcnt(6)
v_mfma_f32_16x16x32_bf16 v[28:31], v[72:75], v[136:139], 0
v_mfma_f32_16x16x32_bf16 v[32:35], v[88:91], v[136:139], 0
s_waitcnt lgkmcnt(4)
v_mfma_f32_16x16x32_bf16 v[28:31], v[76:79], v[140:143], v[28:31]
v_mfma_f32_16x16x32_bf16 v[32:35], v[92:95], v[140:143], v[32:35]
s_waitcnt lgkmcnt(2)
v_mfma_f32_16x16x32_bf16 v[28:31], v[80:83], v[144:147], v[28:31]
v_mfma_f32_16x16x32_bf16 v[32:35], v[96:99], v[144:147], v[32:35]
s_waitcnt lgkmcnt(0)
v_mfma_f32_16x16x32_bf16 v[28:31], v[84:87], v[148:151], v[28:31]
v_mfma_f32_16x16x32_bf16 v[32:35], v[100:103], v[148:151], v[32:35]
s_nop 7
v_max3_f32 v157, v28, v29, v30
v_max3_f32 v158, v31, v32, v33
v_max3_f32 v157, v157, v34, v35
v_max_f32 v157, v157, v158
v_mov_b32 v158, v157
s_nop 1
v_permlane16_swap_b32 v157, v158
s_nop 0
v_max_f32 v157, v157, v158
v_mov_b32 v158, v157
s_nop 1
v_permlane32_swap_b32 v157, v158
s_nop 0
v_max_f32 v157, v157, v158
ds_write_b32 v159, v157
s_waitcnt lgkmcnt(0)
s_barrier
ds_read_b128 v[160:163], v155
ds_read_b128 v[164:167], v155 offset:16
s_mov_b32 s64, 0x3e0293ee
s_waitcnt lgkmcnt(0)
v_max3_f32 v157, v160, v161, v162
v_max3_f32 v158, v163, v164, v165
v_max3_f32 v157, v157, v166, v167
v_max_f32 v157, v157, v158
v_mul_f32 v157, s64, v157
v_fma_f32 v28, v28, s64, -v157
v_fma_f32 v29, v29, s64, -v157
v_fma_f32 v30, v30, s64, -v157
v_fma_f32 v31, v31, s64, -v157
v_fma_f32 v32, v32, s64, -v157
v_fma_f32 v33, v33, s64, -v157
v_fma_f32 v34, v34, s64, -v157
v_fma_f32 v35, v35, s64, -v157
v_exp_f32 v28, v28
v_exp_f32 v29, v29
v_exp_f32 v30, v30
v_exp_f32 v31, v31
v_exp_f32 v32, v32
v_exp_f32 v33, v33
v_exp_f32 v34, v34
v_exp_f32 v35, v35
s_nop 0
v_pk_add_f32 v[160:161], v[28:29], v[30:31]
v_pk_add_f32 v[162:163], v[32:33], v[34:35]
v_pk_add_f32 v[160:161], v[160:161], v[162:163]
v_add_f32 v158, v160, v161
v_mov_b32 v160, v158
s_nop 1
v_permlane16_swap_b32 v158, v160
s_nop 0
v_add_f32 v158, v158, v160
v_mov_b32 v160, v158
s_nop 1
v_permlane32_swap_b32 v158, v160
s_nop 0
v_add_f32 v158, v158, v160
ds_write_b32 v159, v158 offset:64
v_mov_b32 v15, 79296
v_mov_b32 v156, 1
s_mov_b32 exec_lo, 0x1
s_mov_b32 exec_hi, 0x0
ds_add_u32 v15, v156 offset:32
s_mov_b64 exec, -1
v_cvt_pk_bf16_f32 v28, v28, v28
v_cvt_pk_bf16_f32 v29, v29, v29
v_cvt_pk_bf16_f32 v30, v30, v30
v_cvt_pk_bf16_f32 v31, v31, v31
v_cvt_pk_bf16_f32 v32, v32, v32
v_cvt_pk_bf16_f32 v33, v33, v33
v_cvt_pk_bf16_f32 v34, v34, v34
v_cvt_pk_bf16_f32 v35, v35, v35
v_and_b32 v72, v28, v8
v_and_b32 v73, v28, v9
v_and_b32 v74, v28, v10
v_and_b32 v75, v28, v11
v_and_b32 v76, v29, v8
v_and_b32 v77, v29, v9
v_and_b32 v78, v29, v10
v_and_b32 v79, v29, v11
v_and_b32 v80, v30, v8
v_and_b32 v81, v30, v9
v_and_b32 v82, v30, v10
v_and_b32 v83, v30, v11
v_and_b32 v84, v31, v8
v_and_b32 v85, v31, v9
v_and_b32 v86, v31, v10
v_and_b32 v87, v31, v11
v_and_b32 v88, v32, v8
v_and_b32 v89, v32, v9
v_and_b32 v90, v32, v10
v_and_b32 v91, v32, v11
v_and_b32 v92, v33, v8
v_and_b32 v93, v33, v9
v_and_b32 v94, v33, v10
v_and_b32 v95, v33, v11
v_and_b32 v96, v34, v8
v_and_b32 v97, v34, v9
v_and_b32 v98, v34, v10
v_and_b32 v99, v34, v11
v_and_b32 v100, v35, v8
v_and_b32 v101, v35, v9
v_and_b32 v102, v35, v10
v_and_b32 v103, v35, v11
v_lshrrev_b32 v12, 5, v1
v_lshlrev_b32 v12, 9, v12
v_and_b32 v156, 15, v1
v_lshl_add_u32 v12, v156, 5, v12
v_and_b32 v157, 1, v6
v_lshl_add_u32 v12, v157, 4, v12
s_lshl_b32 s64, s3, 10
s_add_u32 s64, s64, 81920
v_add_u32 v12, s64, v12
v_lshlrev_b32 v156, 11, v156
s_lshl_b32 s64, s66, 15
s_add_u32 s64, s64, 1441792
v_add_u32 v156, s64, v156
s_lshl_b32 s64, s67, 3
s_add_u32 s64, s64, s3
s_lshl_b32 s65, s64, 10
s_lshl_b32 s64, s64, 6
v_lshl_add_u32 v162, v6, 4, s64
v_add_u32 v162, v162, v156
s_lshl_b32 s64, s66, 14
s_add_u32 s64, s64, s65
s_add_u32 s64, s64, 393216
v_add_u32 v160, s64, v4
v_mov_b32 v15, 79296
ds_read_b32 v156, v15
ds_read_b64 v[158:159], v15 offset:16
buffer_load_dwordx4 v[40:43], v2, s[44:47], s30 offen offset:0 nt
buffer_load_dwordx4 v[44:47], v2, s[44:47], s30 offen offset:1152 nt
s_waitcnt lgkmcnt(0)
v_cmp_eq_u32 vcc, 1, v156
s_cbranch_vccz L_pvl
ds_read_b64 v[140:141], v15 offset:8
ds_read_b64 v[136:137], v13
ds_read_b64 v[138:139], v13 offset:512
v_bfrev_b32 v155, 1
s_waitcnt lgkmcnt(0)
v_readfirstlane_b32 s90, v140
v_readfirstlane_b32 s92, v141
s_add_u32 s90, s90, s93
s_add_u32 s91, s90, 147456
s_mov_b32 s95, 1
s_cmp_eq_u32 s92, 0
s_cbranch_scc1 L_pv0
v_cmp_eq_u32 vcc, 0, v136
s_nop 1
v_cndmask_b32 v142, v2, v155, vcc
buffer_load_dwordx4 v[48:51], v142, s[48:51], s90 offen offset:0 nt
v_cmp_eq_u32 vcc, 0, v137
s_nop 1
v_cndmask_b32 v143, v2, v155, vcc
buffer_load_dwordx4 v[52:55], v143, s[48:51], s90 offen offset:1152 nt
s_cmp_eq_u32 s92, 1
s_cbranch_scc1 L_pv1
v_cmp_eq_u32 vcc, 0, v138
s_nop 1
v_cndmask_b32 v144, v2, v155, vcc
buffer_load_dwordx4 v[56:59], v144, s[48:51], s91 offen offset:0 nt
v_cmp_eq_u32 vcc, 0, v139
s_nop 1
v_cndmask_b32 v145, v2, v155, vcc
buffer_load_dwordx4 v[60:63], v145, s[48:51], s91 offen offset:1152 nt
s_waitcnt vmcnt(13)
v_mfma_f32_16x16x32_bf16 v[36:39], v[72:75], v[104:107], 0
s_waitcnt vmcnt(12)
v_mfma_f32_16x16x32_bf16 v[36:39], v[76:79], v[108:111], v[36:39]
s_waitcnt vmcnt(11)
v_mfma_f32_16x16x32_bf16 v[36:39], v[80:83], v[112:115], v[36:39]
s_waitcnt vmcnt(10)
v_mfma_f32_16x16x32_bf16 v[36:39], v[84:87], v[116:119], v[36:39]
s_waitcnt vmcnt(9)
v_mfma_f32_16x16x32_bf16 v[36:39], v[88:91], v[120:123], v[36:39]
s_waitcnt vmcnt(8)
v_mfma_f32_16x16x32_bf16 v[36:39], v[92:95], v[124:127], v[36:39]
s_waitcnt vmcnt(7)
v_mfma_f32_16x16x32_bf16 v[36:39], v[96:99], v[128:131], v[36:39]
s_waitcnt vmcnt(6)
v_mfma_f32_16x16x32_bf16 v[36:39], v[100:103], v[132:135], v[36:39]
s_branch L_pve
L_pv1:
s_waitcnt vmcnt(11)
v_mfma_f32_16x16x32_bf16 v[36:39], v[72:75], v[104:107], 0
s_waitcnt vmcnt(10)
v_mfma_f32_16x16x32_bf16 v[36:39], v[76:79], v[108:111], v[36:39]
s_waitcnt vmcnt(9)
v_mfma_f32_16x16x32_bf16 v[36:39], v[80:83], v[112:115], v[36:39]
s_waitcnt vmcnt(8)
v_mfma_f32_16x16x32_bf16 v[36:39], v[84:87], v[116:119], v[36:39]
s_waitcnt vmcnt(7)
v_mfma_f32_16x16x32_bf16 v[36:39], v[88:91], v[120:123], v[36:39]
s_waitcnt vmcnt(6)
v_mfma_f32_16x16x32_bf16 v[36:39], v[92:95], v[124:127], v[36:39]
s_waitcnt vmcnt(5)
v_mfma_f32_16x16x32_bf16 v[36:39], v[96:99], v[128:131], v[36:39]
s_waitcnt vmcnt(4)
v_mfma_f32_16x16x32_bf16 v[36:39], v[100:103], v[132:135], v[36:39]
s_branch L_pve
L_pvl:
s_mov_b32 s95, 0
L_pv0:
s_waitcnt vmcnt(9)
v_mfma_f32_16x16x32_bf16 v[36:39], v[72:75], v[104:107], 0
s_waitcnt vmcnt(8)
v_mfma_f32_16x16x32_bf16 v[36:39], v[76:79], v[108:111], v[36:39]
s_waitcnt vmcnt(7)
v_mfma_f32_16x16x32_bf16 v[36:39], v[80:83], v[112:115], v[36:39]
s_waitcnt vmcnt(6)
v_mfma_f32_16x16x32_bf16 v[36:39], v[84:87], v[116:119], v[36:39]
s_waitcnt vmcnt(5)
v_mfma_f32_16x16x32_bf16 v[36:39], v[88:91], v[120:123], v[36:39]
s_waitcnt vmcnt(4)
v_mfma_f32_16x16x32_bf16 v[36:39], v[92:95], v[124:127], v[36:39]
s_waitcnt vmcnt(3)
v_mfma_f32_16x16x32_bf16 v[36:39], v[96:99], v[128:131], v[36:39]
s_waitcnt vmcnt(2)
v_mfma_f32_16x16x32_bf16 v[36:39], v[100:103], v[132:135], v[36:39]
L_pve:
v_mov_b32 v156, 1
s_nop 6
ds_write_b128 v12, v[36:39]
s_mov_b32 exec_lo, 0x1
s_mov_b32 exec_hi, 0x0
ds_add_u32 v15, v156 offset:4
s_mov_b64 exec, -1
s_cmp_eq_u32 s95, 1
s_cbranch_scc1 L_hx
L_hw:
ds_read_b32 v156, v15
s_waitcnt lgkmcnt(0)
v_cmp_eq_u32 vcc, 1, v156
s_cbranch_vccnz L_hgo
s_sleep 1
s_branch L_hw
L_hgo:
ds_read_b64 v[140:141], v15 offset:8
ds_read_b64 v[136:137], v13
ds_read_b64 v[138:139], v13 offset:512
v_bfrev_b32 v155, 1
s_waitcnt lgkmcnt(0)
v_readfirstlane_b32 s90, v140
v_readfirstlane_b32 s92, v141
s_add_u32 s90, s90, s93
s_add_u32 s91, s90, 147456
s_cmp_eq_u32 s92, 0
s_cbranch_scc1 L_hx
v_cmp_eq_u32 vcc, 0, v136
s_nop 1
v_cndmask_b32 v142, v2, v155, vcc
buffer_load_dwordx4 v[48:51], v142, s[48:51], s90 offen offset:0 nt
v_cmp_eq_u32 vcc, 0, v137
s_nop 1
v_cndmask_b32 v143, v2, v155, vcc
buffer_load_dwordx4 v[52:55], v143, s[48:51], s90 offen offset:1152 nt
s_cmp_eq_u32 s92, 1
s_cbranch_scc1 L_hx
v_cmp_eq_u32 vcc, 0, v138
s_nop 1
v_cndmask_b32 v144, v2, v155, vcc
buffer_load_dwordx4 v[56:59], v144, s[48:51], s91 offen offset:0 nt
v_cmp_eq_u32 vcc, 0, v139
s_nop 1
v_cndmask_b32 v145, v2, v155, vcc
buffer_load_dwordx4 v[60:63], v145, s[48:51], s91 offen offset:1152 nt
L_hx:
v_mov_b32 v24, 0
v_mov_b32 v25, 0
v_mov_b32 v26, 0
v_mov_b32 v27, 0
v_and_b32 v16, v136, v8
v_and_b32 v17, v136, v9
v_and_b32 v18, v136, v10
v_and_b32 v19, v136, v11
v_and_b32 v20, v137, v8
v_and_b32 v21, v137, v9
v_and_b32 v22, v137, v10
v_and_b32 v23, v137, v11
v_and_b32 v161, 15, v1
v_mov_b32 v156, 78848
v_lshl_add_u32 v161, v161, 2, v156
v_and_b32 v28, v138, v8
v_and_b32 v29, v138, v9
v_and_b32 v30, v138, v10
v_and_b32 v31, v138, v11
v_and_b32 v32, v139, v8
v_and_b32 v33, v139, v9
v_and_b32 v34, v139, v10
v_and_b32 v35, v139, v11
L_g0:
ds_read_b32 v156, v15 offset:28
s_waitcnt lgkmcnt(0)
v_cmp_eq_u32 vcc, 1, v156
s_cbranch_vccz L_g0
global_load_dwordx4 v[108:111], v160, s[28:29] sc1
L_gw:
ds_read_b32 v156, v15 offset:24
ds_read_b32 v116, v161
s_waitcnt lgkmcnt(0)
v_cmp_eq_u32 vcc, 1, v156
s_cbranch_vccz L_gw
s_waitcnt vmcnt(0)
s_cmp_eq_u32 s92, 0
s_cbranch_scc1 L_ab0
v_mfma_f32_16x16x32_bf16 v[24:27], v[16:19], v[48:51], 0
v_mfma_f32_16x16x32_bf16 v[24:27], v[20:23], v[52:55], v[24:27]
s_cmp_eq_u32 s92, 1
s_cbranch_scc1 L_ab0
v_mfma_f32_16x16x32_bf16 v[24:27], v[28:31], v[56:59], v[24:27]
v_mfma_f32_16x16x32_bf16 v[24:27], v[32:35], v[60:63], v[24:27]
L_ab0:
s_mov_b32 s95, 0
L_og1:
s_waitcnt vmcnt(0)
v_xor_b32 v157, s60, v108
v_bitop3_b32 v157, v109, s61, v157 bitop3:0xbe
v_bitop3_b32 v157, v110, s62, v157 bitop3:0xbe
v_bitop3_b32 v157, v111, s63, v157 bitop3:0xbe
v_and_b32 v157, v7, v157
v_cmp_ne_u32 vcc, 0, v157
s_cbranch_vccz L_od1
s_add_u32 s95, s95, 1
s_cmp_ge_u32 s95, 20000
s_cbranch_scc1 L_od1
s_cmp_gt_u32 s95, 4
s_cselect_b32 s64, s95, 0
s_bitcmp1_b32 s64, 0
s_cbranch_scc1 L_oh1
global_load_dwordx4 v[108:111], v160, s[28:29] sc1
s_branch L_og1
L_oh1:
global_load_dwordx4 v[108:111], v162, s[28:29] offset:0 sc1
s_branch L_og1
L_od1:
v_and_b32 v108, s101, v108
v_and_b32 v109, s101, v109
v_and_b32 v110, s101, v110
v_and_b32 v111, s101, v111
v_mul_f32 v120, v116, v108
v_mul_f32 v121, v116, v109
v_mul_f32 v122, v116, v110
v_mul_f32 v123, v116, v111
v_add_f32_dpp v124, v120, v120 row_ror:8 row_mask:0xf bank_mask:0x3
v_add_f32_dpp v125, v121, v121 row_ror:8 row_mask:0xf bank_mask:0x3
v_add_f32_dpp v124, v122, v122 row_ror:8 row_mask:0xf bank_mask:0xc
v_add_f32_dpp v125, v123, v123 row_ror:8 row_mask:0xf bank_mask:0xc
s_nop 0
v_add_f32_dpp v124, v124, v124 row_half_mirror row_mask:0xf bank_mask:0xf
v_add_f32_dpp v125, v125, v125 row_half_mirror row_mask:0xf bank_mask:0xf
s_nop 0
v_add_f32_dpp v124, v124, v124 quad_perm:[1,0,3,2] row_mask:0xf bank_mask:0xf
v_add_f32_dpp v125, v125, v125 quad_perm:[1,0,3,2] row_mask:0xf bank_mask:0xf
s_nop 0
v_add_f32_dpp v124, v124, v124 quad_perm:[2,3,0,1] row_mask:0xf bank_mask:0xf
v_add_f32_dpp v125, v125, v125 quad_perm:[2,3,0,1] row_mask:0xf bank_mask:0xf
v_cvt_pk_bf16_f32 v124, v124, v124
v_cvt_pk_bf16_f32 v125, v125, v125
v_pk_mul_f32 v[24:25], v[24:25], v[158:159] op_sel:[0,1] op_sel_hi:[1,1]
v_pk_mul_f32 v[26:27], v[26:27], v[158:159] op_sel:[0,1] op_sel_hi:[1,1]
v_and_b32 v16, v124, v8
v_and_b32 v17, v124, v9
v_and_b32 v18, v124, v10
v_and_b32 v19, v124, v11
v_and_b32 v20, v125, v8
v_and_b32 v21, v125, v9
v_and_b32 v22, v125, v10
v_and_b32 v23, v125, v11
s_nop 0
v_mfma_f32_16x16x32_bf16 v[24:27], v[16:19], v[40:43], v[24:27]
v_mfma_f32_16x16x32_bf16 v[24:27], v[20:23], v[44:47], v[24:27]
L_pw:
s_mov_b32 exec_lo, 0xff00ff
s_mov_b32 exec_hi, 0xff00ff00
s_nop 5
ds_write_b128 v14, v[24:27]
s_waitcnt lgkmcnt(0)
s_barrier
s_branch L_fin
L_cwave:
s_mul_i32 s31, s97, 29
s_lshr_b32 s31, s31, 8
s_mul_i32 s65, s31, 9
s_sub_u32 s93, s97, s65
s_add_u32 s30, s93, s96
s_sub_u32 s65, s30, 9
s_cmp_ge_u32 s30, 9
s_cselect_b32 s30, s65, s30
s_and_b32 s64, s30, 3
s_lshl_b32 s64, s64, 6
s_lshr_b32 s65, s30, 2
s_lshl_b32 s65, s65, 2
s_add_u32 s65, s65, s64
s_mov_b32 s66, 1
s_cmp_eq_u32 s95, 2
s_cbranch_scc1 L_cnb1
s_barrier
s_barrier
s_cmp_lt_u32 s93, 5
s_cbranch_scc1 L_cx
s_sleep 12
L_cx:
s_atomic_add s66, s[26:27], s65 glc
s_branch L_cnb2
L_cnb1:
s_sleep 60
s_atomic_add s66, s[26:27], s65 glc
L_cnb2:
v_lshrrev_b32 v104, 2, v1
v_and_b32 v156, 3, v1
v_lshlrev_b32 v105, 8, v104
v_lshl_add_u32 v105, v156, 4, v105
s_lshr_b32 s64, s2, 2
s_lshl_b32 s65, s64, 13
s_and_b32 s67, s2, 3
s_lshl_b32 s68, s67, 6
s_add_u32 s65, s65, s68
s_add_u32 s65, s65, 2097152
v_add_u32 v105, s65, v105
v_add_u32 v106, 0x1000, v105
s_lshl_b32 s65, s64, 7
s_lshl_b32 s67, s67, 5
s_add_u32 s65, s65, s67
v_lshlrev_b32 v112, 3, v156
v_bfe_u32 v156, v1, 2, 2
v_lshl_add_u32 v112, v156, 1, v112
v_add_u32 v112, s65, v112
v_and_b32 v156, 3, v104
v_lshrrev_b32 v157, 2, v104
s_add_u32 s65, s64, 9
v_sub_u32 v107, s65, v157
v_subrev_u32 v108, 9, v107
v_min_u32 v107, v107, v108
v_cmp_gt_u32 vcc, 5, v107
v_cmp_ne_u32 s[32:33], 3, v156
s_or_b64 s[32:33], s[32:33], vcc
s_add_u32 s65, s64, 5
v_sub_u32 v107, s65, v157
v_subrev_u32 v108, 9, v107
v_min_u32 v107, v107, v108
v_cmp_gt_u32 vcc, 5, v107
v_cmp_ne_u32 s[34:35], 3, v156
s_or_b64 s[34:35], s[34:35], vcc
s_waitcnt lgkmcnt(0)
s_lshl_b32 s64, s66, 1
s_add_u32 s65, s66, 12
s_cmp_lt_u32 s66, 12
s_cselect_b32 s64, s64, s65
s_cselect_b32 s67, 2, 1
s_cmp_lt_u32 s66, 24
s_cselect_b32 s67, s67, 0
s_cselect_b32 s92, s64, 0
s_mul_i32 s64, s92, 147456
v_mov_b32 v15, 79296
v_mov_b32 v156, s64
v_mov_b32 v157, s67
ds_write_b64 v15, v[156:157] offset:8
s_cmp_lg_u32 s67, 0
s_cbranch_scc1 L_chave
s_waitcnt lgkmcnt(0)
v_mov_b32 v156, 1
ds_write_b32 v15, v156
s_barrier
s_barrier
s_branch L_cjoin
L_chave:
v_and_b32 v156, 31, v1
v_lshlrev_b32 v96, 4, v156
v_lshrrev_b32 v157, 5, v1
s_movk_i32 s64, 18432
v_mad_u32_u24 v96, v157, s64, v96
s_lshl_b32 s64, s92, 9
s_add_u32 s64, s64, 73728
v_add_u32 v96, s64, v96
v_add_u32 v97, 40960, v96
v_add_u32 v98, 81920, v96
v_add_u32 v99, 122880, v96
v_add_u32 v100, 163840, v96
v_lshrrev_b32 v156, 4, v156
s_lshl_b32 s64, s92, 1
v_add_u32 v156, s64, v156
v_and_b32 v157, 7, v156
v_cmp_eq_u32 s[52:53], 3, v157
v_add_u32 v156, 2, v156
v_and_b32 v157, 7, v156
v_cmp_eq_u32 s[54:55], 3, v157
v_mov_b32 v52, 0
v_mov_b32 v53, 0
v_mov_b32 v54, 0
v_mov_b32 v55, 0
v_mov_b32 v56, 0
v_mov_b32 v57, 0
v_mov_b32 v58, 0
v_mov_b32 v59, 0
v_mov_b32 v72, 0
v_mov_b32 v73, 0
v_mov_b32 v74, 0
v_mov_b32 v75, 0
v_mov_b32 v76, 0
v_mov_b32 v77, 0
v_mov_b32 v78, 0
v_mov_b32 v79, 0
s_sleep 30
s_cmp_eq_u32 s67, 1
s_cselect_b64 s[64:65], 0, s[54:55]
s_or_b64 s[64:65], s[64:65], s[52:53]
s_cbranch_scc0 L_hx0
s_sleep 16
L_hx0:
global_load_dwordx4 v[40:43], v96, s[28:29] offset:0 sc1
global_load_dwordx4 v[44:47], v97, s[28:29] offset:0 sc1
global_load_dwordx4 v[48:51], v98, s[28:29] offset:0 sc1
s_mov_b64 exec, s[52:53]
s_cbranch_execz L_hj1_0
global_load_dwordx4 v[52:55], v99, s[28:29] offset:0 sc1
global_load_dwordx4 v[56:59], v100, s[28:29] offset:0 sc1
L_hj1_0:
s_mov_b64 exec, -1
s_cmp_eq_u32 s67, 1
s_cbranch_scc1 L_hi1
global_load_dwordx4 v[60:63], v96, s[28:29] offset:512 sc1
global_load_dwordx4 v[64:67], v97, s[28:29] offset:512 sc1
global_load_dwordx4 v[68:71], v98, s[28:29] offset:512 sc1
s_mov_b64 exec, s[54:55]
s_cbranch_execz L_hj1_1
global_load_dwordx4 v[72:75], v99, s[28:29] offset:512 sc1
global_load_dwordx4 v[76:79], v100, s[28:29] offset:512 sc1
L_hj1_1:
s_mov_b64 exec, -1
L_hi1:
s_barrier
s_barrier
s_movk_i32 s95, 20000
L_hchk:
s_waitcnt vmcnt(0)
v_xor_b32 v157, s60, v40
v_bitop3_b32 v157, v41, s61, v157 bitop3:0xbe
v_bitop3_b32 v157, v42, s62, v157 bitop3:0xbe
v_bitop3_b32 v157, v43, s63, v157 bitop3:0xbe
v_bitop3_b32 v157, v44, s60, v157 bitop3:0xbe
v_bitop3_b32 v157, v45, s61, v157 bitop3:0xbe
v_bitop3_b32 v157, v46, s62, v157 bitop3:0xbe
v_bitop3_b32 v157, v47, s63, v157 bitop3:0xbe
v_bitop3_b32 v157, v48, s60, v157 bitop3:0xbe
v_bitop3_b32 v157, v49, s61, v157 bitop3:0xbe
v_bitop3_b32 v157, v50, s62, v157 bitop3:0xbe
v_bitop3_b32 v157, v51, s63, v157 bitop3:0xbe
s_mov_b64 exec, s[52:53]
v_bitop3_b32 v157, v52, s60, v157 bitop3:0xbe
v_bitop3_b32 v157, v53, s61, v157 bitop3:0xbe
v_bitop3_b32 v157, v54, s62, v157 bitop3:0xbe
v_bitop3_b32 v157, v55, s63, v157 bitop3:0xbe
v_bitop3_b32 v157, v56, s60, v157 bitop3:0xbe
v_bitop3_b32 v157, v57, s61, v157 bitop3:0xbe
v_bitop3_b32 v157, v58, s62, v157 bitop3:0xbe
v_bitop3_b32 v157, v59, s63, v157 bitop3:0xbe
s_mov_b64 exec, -1
s_cmp_eq_u32 s67, 1
s_cbranch_scc1 L_hc1
v_bitop3_b32 v157, v60, s60, v157 bitop3:0xbe
v_bitop3_b32 v157, v61, s61, v157 bitop3:0xbe
v_bitop3_b32 v157, v62, s62, v157 bitop3:0xbe
v_bitop3_b32 v157, v63, s63, v157 bitop3:0xbe
v_bitop3_b32 v157, v64, s60, v157 bitop3:0xbe
v_bitop3_b32 v157, v65, s61, v157 bitop3:0xbe
v_bitop3_b32 v157, v66, s62, v157 bitop3:0xbe
v_bitop3_b32 v157, v67, s63, v157 bitop3:0xbe
v_bitop3_b32 v157, v68, s60, v157 bitop3:0xbe
v_bitop3_b32 v157, v69, s61, v157 bitop3:0xbe
v_bitop3_b32 v157, v70, s62, v157 bitop3:0xbe
v_bitop3_b32 v157, v71, s63, v157 bitop3:0xbe
s_mov_b64 exec, s[54:55]
v_bitop3_b32 v157, v72, s60, v157 bitop3:0xbe
v_bitop3_b32 v157, v73, s61, v157 bitop3:0xbe
v_bitop3_b32 v157, v74, s62, v157 bitop3:0xbe
v_bitop3_b32 v157, v75, s63, v157 bitop3:0xbe
v_bitop3_b32 v157, v76, s60, v157 bitop3:0xbe
v_bitop3_b32 v157, v77, s61, v157 bitop3:0xbe
v_bitop3_b32 v157, v78, s62, v157 bitop3:0xbe
v_bitop3_b32 v157, v79, s63, v157 bitop3:0xbe
s_mov_b64 exec, -1
L_hc1:
v_and_b32 v157, v7, v157
v_cmp_ne_u32 vcc, 0, v157
s_cbranch_vccz L_hok
s_sleep 2
global_load_dwordx4 v[40:43], v96, s[28:29] offset:0 sc1
global_load_dwordx4 v[44:47], v97, s[28:29] offset:0 sc1
global_load_dwordx4 v[48:51], v98, s[28:29] offset:0 sc1
s_mov_b64 exec, s[52:53]
s_cbranch_execz L_hj2_0
global_load_dwordx4 v[52:55], v99, s[28:29] offset:0 sc1
global_load_dwordx4 v[56:59], v100, s[28:29] offset:0 sc1
L_hj2_0:
s_mov_b64 exec, -1
s_cmp_eq_u32 s67, 1
s_cbranch_scc1 L_hi2
global_load_dwordx4 v[60:63], v96, s[28:29] offset:512 sc1
global_load_dwordx4 v[64:67], v97, s[28:29] offset:512 sc1
global_load_dwordx4 v[68:71], v98, s[28:29] offset:512 sc1
s_mov_b64 exec, s[54:55]
s_cbranch_execz L_hj2_1
global_load_dwordx4 v[72:75], v99, s[28:29] offset:512 sc1
global_load_dwordx4 v[76:79], v100, s[28:29] offset:512 sc1
L_hj2_1:
s_mov_b64 exec, -1
L_hi2:
s_sub_u32 s95, s95, 1
s_cbranch_scc0 L_hchk
L_hok:
s_mov_b32 s64, 0xffff0000
v_add_u32 v155, 70144, v4
v_and_b32 v40, s101, v40
v_and_b32 v41, s101, v41
v_and_b32 v42, s101, v42
v_and_b32 v43, s101, v43
v_and_b32 v44, s101, v44
v_and_b32 v45, s101, v45
v_and_b32 v46, s101, v46
v_and_b32 v47, s101, v47
v_and_b32 v48, s101, v48
v_and_b32 v49, s101, v49
v_and_b32 v50, s101, v50
v_and_b32 v51, s101, v51
v_and_b32 v52, s101, v52
v_and_b32 v53, s101, v53
v_and_b32 v54, s101, v54
v_and_b32 v55, s101, v55
v_and_b32 v56, s101, v56
v_and_b32 v57, s101, v57
v_and_b32 v58, s101, v58
v_and_b32 v59, s101, v59
v_pk_add_f32 v[116:117], v[40:41], v[44:45]
v_pk_add_f32 v[118:119], v[42:43], v[46:47]
v_pk_add_f32 v[124:125], v[48:49], v[52:53]
v_pk_add_f32 v[126:127], v[50:51], v[54:55]
v_pk_add_f32 v[116:117], v[116:117], v[56:57]
v_pk_add_f32 v[118:119], v[118:119], v[58:59]
v_pk_add_f32 v[116:117], v[116:117], v[124:125]
v_pk_add_f32 v[118:119], v[118:119], v[126:127]
v_cvt_pk_bf16_f32 v116, v116, v116
v_cvt_pk_bf16_f32 v117, v117, v117
v_cvt_pk_bf16_f32 v118, v118, v118
v_cvt_pk_bf16_f32 v119, v119, v119
v_and_b32 v116, s64, v116
v_and_b32 v117, s64, v117
v_and_b32 v118, s64, v118
v_and_b32 v119, s64, v119
v_mov_b32 v120, v116
v_mov_b32 v121, v117
v_mov_b32 v122, v118
v_mov_b32 v123, v119
s_nop 0
v_permlane32_swap_b32 v120, v124
v_permlane32_swap_b32 v121, v125
v_permlane32_swap_b32 v122, v126
v_permlane32_swap_b32 v123, v127
v_max_f32 v116, 0, v116
v_max_f32 v117, 0, v117
v_max_f32 v118, 0, v118
v_max_f32 v119, 0, v119
v_fma_f32 v116, v116, v124, 0
v_fma_f32 v117, v117, v125, 0
v_fma_f32 v118, v118, v126, 0
v_fma_f32 v119, v119, v127, 0
v_cvt_pk_bf16_f32 v116, v116, v116
v_cvt_pk_bf16_f32 v117, v117, v117
v_cvt_pk_bf16_f32 v118, v118, v118
v_cvt_pk_bf16_f32 v119, v119, v119
s_mov_b32 exec_lo, 0xffffffff
s_mov_b32 exec_hi, 0x0
ds_write_b128 v155, v[116:119] offset:0
s_mov_b64 exec, -1
s_nop 0
s_cmp_eq_u32 s67, 1
s_cbranch_scc1 L_hw1
v_and_b32 v60, s101, v60
v_and_b32 v61, s101, v61
v_and_b32 v62, s101, v62
v_and_b32 v63, s101, v63
v_and_b32 v64, s101, v64
v_and_b32 v65, s101, v65
v_and_b32 v66, s101, v66
v_and_b32 v67, s101, v67
v_and_b32 v68, s101, v68
v_and_b32 v69, s101, v69
v_and_b32 v70, s101, v70
v_and_b32 v71, s101, v71
v_and_b32 v72, s101, v72
v_and_b32 v73, s101, v73
v_and_b32 v74, s101, v74
v_and_b32 v75, s101, v75
v_and_b32 v76, s101, v76
v_and_b32 v77, s101, v77
v_and_b32 v78, s101, v78
v_and_b32 v79, s101, v79
v_pk_add_f32 v[116:117], v[60:61], v[64:65]
v_pk_add_f32 v[118:119], v[62:63], v[66:67]
v_pk_add_f32 v[124:125], v[68:69], v[72:73]
v_pk_add_f32 v[126:127], v[70:71], v[74:75]
v_pk_add_f32 v[116:117], v[116:117], v[76:77]
v_pk_add_f32 v[118:119], v[118:119], v[78:79]
v_pk_add_f32 v[116:117], v[116:117], v[124:125]
v_pk_add_f32 v[118:119], v[118:119], v[126:127]
v_cvt_pk_bf16_f32 v116, v116, v116
v_cvt_pk_bf16_f32 v117, v117, v117
v_cvt_pk_bf16_f32 v118, v118, v118
v_cvt_pk_bf16_f32 v119, v119, v119
v_and_b32 v116, s64, v116
v_and_b32 v117, s64, v117
v_and_b32 v118, s64, v118
v_and_b32 v119, s64, v119
v_mov_b32 v120, v116
v_mov_b32 v121, v117
v_mov_b32 v122, v118
v_mov_b32 v123, v119
s_nop 0
v_permlane32_swap_b32 v120, v124
v_permlane32_swap_b32 v121, v125
v_permlane32_swap_b32 v122, v126
v_permlane32_swap_b32 v123, v127
v_max_f32 v116, 0, v116
v_max_f32 v117, 0, v117
v_max_f32 v118, 0, v118
v_max_f32 v119, 0, v119
v_fma_f32 v116, v116, v124, 0
v_fma_f32 v117, v117, v125, 0
v_fma_f32 v118, v118, v126, 0
v_fma_f32 v119, v119, v127, 0
v_cvt_pk_bf16_f32 v116, v116, v116
v_cvt_pk_bf16_f32 v117, v117, v117
v_cvt_pk_bf16_f32 v118, v118, v118
v_cvt_pk_bf16_f32 v119, v119, v119
s_mov_b32 exec_lo, 0xffffffff
s_mov_b32 exec_hi, 0x0
ds_write_b128 v155, v[116:119] offset:512
s_mov_b64 exec, -1
s_nop 0
L_hw1:
s_waitcnt lgkmcnt(0)
v_mov_b32 v156, 1
ds_write_b32 v15, v156
L_cjoin:
s_waitcnt vmcnt(0)
s_cmp_lt_u32 s93, 5
s_cbranch_scc1 L_cb6
s_mul_i32 s66, s31, 3
s_add_u32 s66, s66, 0
v_lshl_add_u32 v153, v6, 1, v152
s_movk_i32 s64, 2304
v_mad_u32_u24 v2, v153, s64, v154
s_add_u32 s67, s96, 8
s_lshl_b32 s64, s67, 1
s_add_u32 s64, s64, 1
s_mul_i32 s64, s64, 147456
s_mul_i32 s65, s66, 18432
s_add_u32 s64, s64, s65
s_lshl_b32 s65, s30, 7
s_add_u32 s90, s64, s65
s_add_u32 s68, s66, 8
s_lshl_b32 s64, s67, 14
s_lshl_b32 s65, s68, 10
s_add_u32 s64, s64, s65
s_add_u32 s64, s64, 393216
v_add_u32 v136, s64, v4
v_and_b32 v156, 15, v1
s_lshl_b32 s64, s67, 9
s_add_u32 s64, s64, 655616
v_lshl_add_u32 v137, v156, 4, s64
s_lshl_b32 s64, s67, 15
s_add_u32 s64, s64, 1441792
v_lshl_add_u32 v139, v156, 11, s64
s_lshl_b32 s64, s68, 6
v_lshl_add_u32 v138, v6, 4, s64
v_add_u32 v138, v138, v139
v_add_u32 v139, 1040, v139
v_lshlrev_b32 v14, 1, v154
v_lshl_add_u32 v14, v152, 8, v14
v_and_b32 v156, 1, v6
v_lshl_add_u32 v14, v156, 4, v14
s_lshl_b32 s64, 0, 9
s_add_u32 s64, s64, 4096
v_add_u32 v14, s64, v14
v_mov_b32 v140, 0
v_mov_b32 v141, 0
v_mov_b32 v142, 0
v_mov_b32 v143, 0
v_mov_b32 v144, 0
v_mov_b32 v145, 0
v_mov_b32 v146, 0
v_mov_b32 v147, 0
v_mov_b32 v24, 0
v_mov_b32 v25, 0
v_mov_b32 v26, 0
v_mov_b32 v27, 0
s_branch L_xpath
L_cb6:
v_mov_b32 v28, 0
v_mov_b32 v29, 0
v_mov_b32 v30, 0
v_mov_b32 v31, 0
s_movk_i32 s95, 20000
s_barrier
s_cmp_ge_u32 s2, 36
s_cbranch_scc1 L_fin
s_sleep 8
s_mov_b64 exec, s[32:33]
global_load_dwordx4 v[72:75], v105, s[28:29] offset:0 sc1
s_mov_b64 exec, s[34:35]
global_load_dwordx4 v[76:79], v106, s[28:29] offset:0 sc1
s_sleep 6
L_wpoll:
s_mov_b64 exec, s[32:33]
global_load_dwordx4 v[88:91], v105, s[28:29] offset:0 sc1
s_mov_b64 exec, s[34:35]
global_load_dwordx4 v[92:95], v106, s[28:29] offset:0 sc1
s_mov_b64 s[48:49], 0
s_mov_b64 exec, s[32:33]
s_cbranch_execz L_wc0_0
s_waitcnt vmcnt(3)
v_xor_b32 v157, s60, v72
v_bitop3_b32 v157, v73, s61, v157 bitop3:0xbe
v_bitop3_b32 v157, v74, s62, v157 bitop3:0xbe
v_bitop3_b32 v157, v75, s63, v157 bitop3:0xbe
v_and_b32 v157, v7, v157
v_cmp_ne_u32 s[32:33], 0, v157
s_andn2_b64 exec, exec, s[32:33]
v_and_b32 v72, s101, v72
v_and_b32 v73, s101, v73
v_and_b32 v74, s101, v74
v_and_b32 v75, s101, v75
v_pk_add_f32 v[28:29], v[28:29], v[72:73]
v_pk_add_f32 v[30:31], v[30:31], v[74:75]
s_or_b64 s[48:49], s[48:49], s[32:33]
L_wc0_0:
s_mov_b64 exec, s[34:35]
s_cbranch_execz L_wc0_1
s_waitcnt vmcnt(2)
v_xor_b32 v157, s60, v76
v_bitop3_b32 v157, v77, s61, v157 bitop3:0xbe
v_bitop3_b32 v157, v78, s62, v157 bitop3:0xbe
v_bitop3_b32 v157, v79, s63, v157 bitop3:0xbe
v_and_b32 v157, v7, v157
v_cmp_ne_u32 s[34:35], 0, v157
s_andn2_b64 exec, exec, s[34:35]
v_and_b32 v76, s101, v76
v_and_b32 v77, s101, v77
v_and_b32 v78, s101, v78
v_and_b32 v79, s101, v79
v_pk_add_f32 v[28:29], v[28:29], v[76:77]
v_pk_add_f32 v[30:31], v[30:31], v[78:79]
s_or_b64 s[48:49], s[48:49], s[34:35]
L_wc0_1:
s_mov_b64 exec, -1
s_cmp_eq_u64 s[48:49], 0
s_cbranch_scc1 L_wdone
s_sleep 1
s_mov_b64 exec, s[32:33]
global_load_dwordx4 v[72:75], v105, s[28:29] offset:0 sc1
s_mov_b64 exec, s[34:35]
global_load_dwordx4 v[76:79], v106, s[28:29] offset:0 sc1
s_mov_b64 s[48:49], 0
s_mov_b64 exec, s[32:33]
s_cbranch_execz L_wc1_0
s_waitcnt vmcnt(3)
v_xor_b32 v157, s60, v88
v_bitop3_b32 v157, v89, s61, v157 bitop3:0xbe
v_bitop3_b32 v157, v90, s62, v157 bitop3:0xbe
v_bitop3_b32 v157, v91, s63, v157 bitop3:0xbe
v_and_b32 v157, v7, v157
v_cmp_ne_u32 s[32:33], 0, v157
s_andn2_b64 exec, exec, s[32:33]
v_and_b32 v88, s101, v88
v_and_b32 v89, s101, v89
v_and_b32 v90, s101, v90
v_and_b32 v91, s101, v91
v_pk_add_f32 v[28:29], v[28:29], v[88:89]
v_pk_add_f32 v[30:31], v[30:31], v[90:91]
s_or_b64 s[48:49], s[48:49], s[32:33]
L_wc1_0:
s_mov_b64 exec, s[34:35]
s_cbranch_execz L_wc1_1
s_waitcnt vmcnt(2)
v_xor_b32 v157, s60, v92
v_bitop3_b32 v157, v93, s61, v157 bitop3:0xbe
v_bitop3_b32 v157, v94, s62, v157 bitop3:0xbe
v_bitop3_b32 v157, v95, s63, v157 bitop3:0xbe
v_and_b32 v157, v7, v157
v_cmp_ne_u32 s[34:35], 0, v157
s_andn2_b64 exec, exec, s[34:35]
v_and_b32 v92, s101, v92
v_and_b32 v93, s101, v93
v_and_b32 v94, s101, v94
v_and_b32 v95, s101, v95
v_pk_add_f32 v[28:29], v[28:29], v[92:93]
v_pk_add_f32 v[30:31], v[30:31], v[94:95]
s_or_b64 s[48:49], s[48:49], s[34:35]
L_wc1_1:
s_mov_b64 exec, -1
s_cmp_eq_u64 s[48:49], 0
s_cbranch_scc1 L_wdone
s_sleep 1
s_sub_u32 s95, s95, 1
s_cbranch_scc0 L_wpoll
L_wdone:
v_add_f32_dpp v32, v28, v28 row_ror:8 row_mask:0xf bank_mask:0x3
v_add_f32_dpp v33, v29, v29 row_ror:8 row_mask:0xf bank_mask:0x3
v_add_f32_dpp v32, v30, v30 row_ror:8 row_mask:0xf bank_mask:0xc
v_add_f32_dpp v33, v31, v31 row_ror:8 row_mask:0xf bank_mask:0xc
s_nop 0
v_add_f32_dpp v34, v32, v32 row_shl:4 row_mask:0xf bank_mask:0x5
v_add_f32_dpp v34, v33, v33 row_shr:4 row_mask:0xf bank_mask:0xa
v_mov_b32 v35, v34
s_nop 1
v_permlane16_swap_b32 v34, v35
s_nop 0
v_add_f32 v34, v34, v35
v_mov_b32 v35, v34
s_nop 1
v_permlane32_swap_b32 v34, v35
s_nop 0
v_add_f32 v34, v34, v35
v_cvt_pk_bf16_f32 v32, v34, v34
s_mov_b32 exec_lo, 0xffff
s_mov_b32 exec_hi, 0x0
global_store_short v112, v32, s[24:25]
s_cmp_lg_u32 s2, 0
s_cbranch_scc1 L_fin
v_mov_b32 v156, s94
v_mov_b32 v155, 0
global_store_dword v155, v156, s[28:29]
s_branch L_fin
L_xpath:
buffer_load_dwordx4 v[128:131], v2, s[44:47], s90 offen offset:0 nt
buffer_load_dwordx4 v[132:135], v2, s[44:47], s90 offen offset:1152 nt
v_mov_b32 v15, 79296
ds_read_b32 v158, v15 offset:16
L_xw:
ds_read_b32 v156, v15 offset:4
s_waitcnt lgkmcnt(0)
v_cmp_eq_u32 vcc, 8, v156
s_cbranch_vccnz L_xg
s_sleep 2
s_branch L_xw
L_xg:
s_mov_b32 s95, 0
s_sleep 12
global_load_dwordx4 v[140:143], v136, s[28:29] sc1
global_load_dwordx4 v[144:147], v137, s[28:29] sc1
s_sleep 4
L_x1:
global_load_dwordx4 v[140:143], v136, s[28:29] sc1
global_load_dwordx4 v[144:147], v137, s[28:29] sc1
s_add_u32 s95, s95, 1
s_waitcnt vmcnt(2)
v_xor_b32 v157, s60, v144
v_bitop3_b32 v157, v145, s61, v157 bitop3:0xbe
v_and_b32 v118, s101, v144
v_and_b32 v119, s101, v145
v_add_f32 v117, v118, v119
v_add_f32 v116, v118, v119
v_bitop3_b32 v157, v146, s62, v157 bitop3:0xbe
v_max_f32_dpp v117, v117, v117 row_ror:8 row_mask:0xf bank_mask:0xf
v_bitop3_b32 v157, v147, s63, v157 bitop3:0xbe
v_bitop3_b32 v157, v140, s60, v157 bitop3:0xbe
v_max_f32_dpp v117, v117, v117 row_ror:4 row_mask:0xf bank_mask:0xf
v_bitop3_b32 v157, v141, s61, v157 bitop3:0xbe
v_bitop3_b32 v157, v142, s62, v157 bitop3:0xbe
v_max_f32_dpp v117, v117, v117 row_ror:2 row_mask:0xf bank_mask:0xf
v_bitop3_b32 v157, v143, s63, v157 bitop3:0xbe
v_and_b32 v157, v7, v157
v_max_f32_dpp v117, v117, v117 row_ror:1 row_mask:0xf bank_mask:0xf
v_cmp_ne_u32 vcc, 0, v157
v_sub_f32 v116, v116, v117
v_exp_f32 v116, v116
s_cbranch_vccz L_xd
s_sleep 4
s_cmp_lt_u32 s95, 48
s_cbranch_scc1 L_x1
L_x2:
s_waitcnt vmcnt(0)
s_add_u32 s95, s95, 1
global_load_dwordx4 v[140:143], v138, s[28:29] sc1
global_load_dwordx4 v[144:147], v139, s[28:29] sc1
s_waitcnt vmcnt(0)
v_xor_b32 v157, s60, v144
v_bitop3_b32 v157, v145, s61, v157 bitop3:0xbe
v_and_b32 v118, s101, v144
v_and_b32 v119, s101, v145
v_add_f32 v117, v118, v119
v_add_f32 v116, v118, v119
v_bitop3_b32 v157, v146, s62, v157 bitop3:0xbe
v_max_f32_dpp v117, v117, v117 row_ror:8 row_mask:0xf bank_mask:0xf
v_bitop3_b32 v157, v147, s63, v157 bitop3:0xbe
v_bitop3_b32 v157, v140, s60, v157 bitop3:0xbe
v_max_f32_dpp v117, v117, v117 row_ror:4 row_mask:0xf bank_mask:0xf
v_bitop3_b32 v157, v141, s61, v157 bitop3:0xbe
v_bitop3_b32 v157, v142, s62, v157 bitop3:0xbe
v_max_f32_dpp v117, v117, v117 row_ror:2 row_mask:0xf bank_mask:0xf
v_bitop3_b32 v157, v143, s63, v157 bitop3:0xbe
v_and_b32 v157, v7, v157
v_max_f32_dpp v117, v117, v117 row_ror:1 row_mask:0xf bank_mask:0xf
v_cmp_ne_u32 vcc, 0, v157
v_sub_f32 v116, v116, v117
v_exp_f32 v116, v116
s_cbranch_vccz L_xd
global_load_dwordx4 v[140:143], v136, s[28:29] sc1
global_load_dwordx4 v[144:147], v137, s[28:29] sc1
s_waitcnt vmcnt(0)
v_xor_b32 v157, s60, v144
v_bitop3_b32 v157, v145, s61, v157 bitop3:0xbe
v_and_b32 v118, s101, v144
v_and_b32 v119, s101, v145
v_add_f32 v117, v118, v119
v_add_f32 v116, v118, v119
v_bitop3_b32 v157, v146, s62, v157 bitop3:0xbe
v_max_f32_dpp v117, v117, v117 row_ror:8 row_mask:0xf bank_mask:0xf
v_bitop3_b32 v157, v147, s63, v157 bitop3:0xbe
v_bitop3_b32 v157, v140, s60, v157 bitop3:0xbe
v_max_f32_dpp v117, v117, v117 row_ror:4 row_mask:0xf bank_mask:0xf
v_bitop3_b32 v157, v141, s61, v157 bitop3:0xbe
v_bitop3_b32 v157, v142, s62, v157 bitop3:0xbe
v_max_f32_dpp v117, v117, v117 row_ror:2 row_mask:0xf bank_mask:0xf
v_bitop3_b32 v157, v143, s63, v157 bitop3:0xbe
v_and_b32 v157, v7, v157
v_max_f32_dpp v117, v117, v117 row_ror:1 row_mask:0xf bank_mask:0xf
v_cmp_ne_u32 vcc, 0, v157
v_sub_f32 v116, v116, v117
v_exp_f32 v116, v116
s_cbranch_vccz L_xd
s_cmp_lt_u32 s95, 20000
s_cbranch_scc1 L_x2
L_xd:
v_and_b32 v118, s101, v146
v_and_b32 v120, s101, v140
v_and_b32 v121, s101, v141
v_and_b32 v122, s101, v142
v_and_b32 v123, s101, v143
v_mul_f32 v118, v116, v118
v_mul_f32 v120, v116, v120
v_mul_f32 v121, v116, v121
v_mul_f32 v122, v116, v122
v_mul_f32 v123, v116, v123
v_add_f32_dpp v118, v118, v118 row_ror:8 row_mask:0xf bank_mask:0xf
v_add_f32_dpp v124, v120, v120 row_ror:8 row_mask:0xf bank_mask:0x3
v_add_f32_dpp v125, v121, v121 row_ror:8 row_mask:0xf bank_mask:0x3
v_add_f32_dpp v118, v118, v118 row_half_mirror row_mask:0xf bank_mask:0xf
v_add_f32_dpp v124, v122, v122 row_ror:8 row_mask:0xf bank_mask:0xc
v_add_f32_dpp v125, v123, v123 row_ror:8 row_mask:0xf bank_mask:0xc
v_add_f32_dpp v118, v118, v118 quad_perm:[1,0,3,2] row_mask:0xf bank_mask:0xf
s_nop 0
v_add_f32_dpp v124, v124, v124 row_half_mirror row_mask:0xf bank_mask:0xf
v_add_f32_dpp v118, v118, v118 quad_perm:[2,3,0,1] row_mask:0xf bank_mask:0xf
v_add_f32_dpp v125, v125, v125 row_half_mirror row_mask:0xf bank_mask:0xf
v_add_f32_dpp v124, v124, v124 quad_perm:[1,0,3,2] row_mask:0xf bank_mask:0xf
v_rcp_f32 v118, v118
v_add_f32_dpp v125, v125, v125 quad_perm:[1,0,3,2] row_mask:0xf bank_mask:0xf
v_add_f32_dpp v124, v124, v124 quad_perm:[2,3,0,1] row_mask:0xf bank_mask:0xf
v_mul_f32 v118, v158, v118
v_add_f32_dpp v125, v125, v125 quad_perm:[2,3,0,1] row_mask:0xf bank_mask:0xf
v_mul_f32 v124, v118, v124
v_mul_f32 v125, v118, v125
v_cvt_pk_bf16_f32 v124, v124, v124
v_cvt_pk_bf16_f32 v125, v125, v125
v_and_b32 v16, v124, v8
v_and_b32 v17, v124, v9
v_and_b32 v18, v124, v10
v_and_b32 v19, v124, v11
v_and_b32 v20, v125, v8
v_and_b32 v21, v125, v9
v_and_b32 v22, v125, v10
v_and_b32 v23, v125, v11
s_nop 0
v_mfma_f32_16x16x32_bf16 v[24:27], v[16:19], v[128:131], 0
v_mfma_f32_16x16x32_bf16 v[24:27], v[20:23], v[132:135], v[24:27]
L_xz:
s_mov_b32 exec_lo, 0xff00ff
s_mov_b32 exec_hi, 0xff00ff00
s_nop 5
ds_write_b128 v14, v[24:27]
s_mov_b64 exec, -1
s_waitcnt lgkmcnt(0)
s_cmp_eq_u32 s3, 8
s_cbranch_scc1 L_cb6
s_barrier
s_branch L_fin
L_ewave:
s_mul_i32 s31, s97, 29
s_lshr_b32 s31, s31, 8
s_mul_i32 s65, s31, 9
s_sub_u32 s93, s97, s65
s_add_u32 s30, s93, s96
s_sub_u32 s65, s30, 9
s_cmp_ge_u32 s30, 9
s_cselect_b32 s30, s65, s30
s_cmp_lt_u32 s93, 5
s_cbranch_scc1 L_end
s_setprio 0
s_sub_u32 s69, s3, 9
s_waitcnt lgkmcnt(0)
s_load_dword s60, s[28:29], 0
s_mul_i32 s66, s31, 3
s_add_u32 s66, s66, s69
v_lshl_add_u32 v153, v6, 1, v152
s_movk_i32 s64, 2304
v_mad_u32_u24 v2, v153, s64, v154
s_add_u32 s67, s96, 8
s_lshl_b32 s64, s67, 1
s_add_u32 s64, s64, 1
s_mul_i32 s64, s64, 147456
s_mul_i32 s65, s66, 18432
s_add_u32 s64, s64, s65
s_lshl_b32 s65, s30, 7
s_add_u32 s90, s64, s65
s_add_u32 s68, s66, 8
s_lshl_b32 s64, s67, 14
s_lshl_b32 s65, s68, 10
s_add_u32 s64, s64, s65
s_add_u32 s64, s64, 393216
v_add_u32 v136, s64, v4
v_and_b32 v156, 15, v1
s_lshl_b32 s64, s67, 9
s_add_u32 s64, s64, 655616
v_lshl_add_u32 v137, v156, 4, s64
s_lshl_b32 s64, s67, 15
s_add_u32 s64, s64, 1441792
v_lshl_add_u32 v139, v156, 11, s64
s_lshl_b32 s64, s68, 6
v_lshl_add_u32 v138, v6, 4, s64
v_add_u32 v138, v138, v139
v_add_u32 v139, 1040, v139
v_lshlrev_b32 v14, 1, v154
v_lshl_add_u32 v14, v152, 8, v14
v_and_b32 v156, 1, v6
v_lshl_add_u32 v14, v156, 4, v14
s_lshl_b32 s64, s69, 9
s_add_u32 s64, s64, 4096
v_add_u32 v14, s64, v14
v_mov_b32 v140, 0
v_mov_b32 v141, 0
v_mov_b32 v142, 0
v_mov_b32 v143, 0
v_mov_b32 v144, 0
v_mov_b32 v145, 0
v_mov_b32 v146, 0
v_mov_b32 v147, 0
v_mov_b32 v24, 0
v_mov_b32 v25, 0
v_mov_b32 v26, 0
v_mov_b32 v27, 0
s_mov_b32 s69, s66
v_mov_b32 v105, 0
v_mov_b32 v106, 0
v_mov_b32 v112, 0
s_mul_i32 s30, s97, 22
s_lshr_b32 s30, s30, 6
s_mul_i32 s92, s30, 3
s_sub_u32 s92, s97, s92
s_cmp_lt_u32 s97, 27
s_cbranch_scc1 L_gm2
s_sub_u32 s30, 3, s96
s_and_b32 s30, s30, 7
s_sub_u32 s92, s97, 24
s_cmp_lt_u32 s97, 29
s_cbranch_scc1 L_gm2
s_mov_b32 s30, 8
s_sub_u32 s92, 33, s97
L_gm2:
s_mul_i32 s64, s96, 9
s_add_u32 s30, s30, s64
s_and_b32 s64, s30, 7
s_cmp_eq_u32 s64, 3
s_cselect_b32 s95, 1, 0
s_cmp_lt_u32 s97, 29
s_cbranch_scc1 L_gn2
s_cmp_eq_u32 s97, 31
s_cselect_b32 s95, 0, s95
s_cmp_eq_u32 s95, 0
s_cselect_b32 s95, 2, s95
L_gn2:
s_mov_b32 s44, s12
s_mov_b32 s45, s13
s_mov_b32 s46, 4718592
s_mov_b32 s47, 0x20000
v_and_b32 v155, 1, v1
v_lshlrev_b32 v155, 4, v155
v_mov_b32 v156, 0xffff
v_lshlrev_b32 v155, v155, v156
v_bfe_u32 v156, v1, 1, 2
v_cmp_eq_u32 vcc, 0, v156
s_nop 1
v_cndmask_b32 v8, 0, v155, vcc
v_cmp_eq_u32 vcc, 1, v156
s_nop 1
v_cndmask_b32 v9, 0, v155, vcc
v_cmp_eq_u32 vcc, 2, v156
s_nop 1
v_cndmask_b32 v10, 0, v155, vcc
v_cmp_eq_u32 vcc, 3, v156
s_nop 1
v_cndmask_b32 v11, 0, v155, vcc
v_mov_b32 v7, 0x3ff
s_waitcnt lgkmcnt(0)
s_mov_b32 s101, 0xfffffc00
s_add_u32 s94, s60, 1
s_and_b32 s60, s94, 0x3ff
s_add_u32 s61, s94, 341
s_and_b32 s61, s61, 0x3ff
s_add_u32 s62, s94, 682
s_and_b32 s62, s62, 0x3ff
s_add_u32 s63, s94, 1023
s_and_b32 s63, s63, 0x3ff
s_barrier
s_barrier
s_barrier
s_cmp_eq_u32 s95, 2
s_cbranch_scc1 L_e2
s_barrier
s_barrier
L_e2:
s_barrier
s_barrier
s_cmp_lt_u32 s69, 8
s_cbranch_scc1 L_xpath
s_branch L_xz
L_swave:
s_mov_b32 s3, 9
s_movk_i32 s58, 1152
s_mov_b32 s59, 0x20000
v_add_u32 v155, 79360, v4
s_waitcnt lgkmcnt(0)
s_mov_b64 s[56:57], s[4:5]
buffer_load_dwordx4 v[72:75], v4, s[56:59], 0 offen
buffer_load_dwordx4 v[76:79], v4, s[56:59], 0 offen offset:1024
s_mov_b64 s[56:57], s[22:23]
s_load_dword s60, s[28:29], 0
s_setprio 0
v_mov_b32 v7, 0x3ff
v_lshlrev_b32 v15, 2, v1
s_mul_i32 s31, s97, 29
s_lshr_b32 s31, s31, 8
s_mul_i32 s65, s31, 9
s_sub_u32 s93, s97, s65
s_add_u32 s30, s93, s96
s_sub_u32 s65, s30, 9
s_cmp_ge_u32 s30, 9
s_cselect_b32 s30, s65, s30
s_lshl_b32 s64, s30, 13
s_lshl_b32 s65, s96, 2
s_add_u32 s65, s65, s31
s_lshl_b32 s65, s65, 8
s_add_u32 s64, s64, s65
s_add_u32 s64, s64, 2097152
v_add_u32 v13, s64, v15
s_lshr_b32 s64, s31, 1
s_lshl_b32 s64, s64, 3
s_add_u32 s66, s64, s96
s_lshl_b32 s64, s66, 15
s_and_b32 s67, s31, 1
s_lshl_b32 s65, s67, 4
s_add_u32 s64, s64, s65
s_add_u32 s64, s64, 1442816
v_and_b32 v156, 15, v1
v_lshl_add_u32 v16, v156, 11, s64
s_lshl_b32 s64, s66, 9
s_lshl_b32 s65, s67, 8
s_add_u32 s64, s64, s65
s_add_u32 s64, s64, 655360
v_lshl_add_u32 v37, v156, 4, s64
s_mov_b32 s69, s93
v_mov_b32 v103, 78848
v_lshl_add_u32 v103, v156, 2, v103
s_mul_i32 s64, s2, 1171
s_lshr_b32 s64, s64, 16
s_mul_i32 s65, s64, 56
s_sub_u32 s65, s2, s65
s_mul_i32 s91, s65, 37
s_lshr_b32 s91, s91, 8
s_add_u32 s91, s91, s65
s_and_b32 s65, s91, 7
s_cmp_ge_u32 s65, 3
s_addc_u32 s91, s91, 0
s_lshl_b32 s65, s96, 3
s_add_u32 s65, s65, 3
s_sub_u32 s31, s97, 28
s_cmp_ge_u32 s97, 28
s_cselect_b32 s91, s65, s91
s_cselect_b32 s64, s31, s64
s_lshl_b32 s64, s64, 14
s_lshl_b32 s91, s91, 8
s_add_u32 s91, s91, s64
s_add_u32 s91, s91, 4096
s_mul_i32 s30, s97, 22
s_lshr_b32 s30, s30, 6
s_mul_i32 s92, s30, 3
s_sub_u32 s92, s97, s92
s_cmp_lt_u32 s97, 27
s_cbranch_scc1 L_gm3
s_sub_u32 s30, 3, s96
s_and_b32 s30, s30, 7
s_sub_u32 s92, s97, 24
s_cmp_lt_u32 s97, 29
s_cbranch_scc1 L_gm3
s_mov_b32 s30, 8
s_sub_u32 s92, 33, s97
L_gm3:
s_mul_i32 s64, s96, 9
s_add_u32 s30, s30, s64
s_and_b32 s64, s30, 7
s_cmp_eq_u32 s64, 3
s_cselect_b32 s95, 1, 0
s_cmp_lt_u32 s97, 29
s_cbranch_scc1 L_gn3
s_cmp_eq_u32 s97, 31
s_cselect_b32 s95, 0, s95
s_cmp_eq_u32 s95, 0
s_cselect_b32 s95, 2, s95
L_gn3:
s_lshl_b32 s31, s98, 4
s_add_u32 s31, s31, s99
s_mul_i32 s64, s92, 40960
s_lshl_b32 s30, s30, 8
s_add_u32 s30, s30, s64
s_add_u32 s30, s30, 73728
s_lshl_b32 s64, s98, 10
s_add_u32 s64, s64, 4096
v_add_u32 v96, s64, v4
v_add_u32 v97, 16384, v96
v_add_u32 v98, 32768, v96
v_add_u32 v99, 49152, v96
s_lshl_b32 s64, s31, 11
s_add_u32 s64, s64, 1441792
v_add_u32 v14, s64, v4
v_lshrrev_b32 v156, 5, v1
v_mov_b32 v39, 79040
v_lshl_add_u32 v39, v156, 5, v39
s_add_u32 s64, s64, 1024
v_lshl_add_u32 v38, v156, 4, s64
s_lshl_b32 s64, s98, 14
s_add_u32 s64, s64, 393216
s_lshl_b32 s65, s99, 4
s_add_u32 s65, s65, s64
v_lshl_add_u32 v19, v1, 8, s65
s_lshl_b32 s65, s99, 10
s_add_u32 s64, s64, s65
v_lshl_add_u32 v36, v1, 7, s64
s_lshl_b32 s64, s98, 9
s_add_u32 s64, s64, 655360
s_lshl_b32 s65, s99, 4
s_add_u32 s65, s65, s64
v_lshl_add_u32 v20, v156, 8, s65
s_sub_u32 s64, s64, 1024
v_lshl_add_u32 v157, v1, 7, s64
v_cmp_gt_u32 vcc, 8, v1
s_nop 1
v_cndmask_b32 v36, v157, v36, vcc
v_add_u32 v102, 81920, v4
s_setprio 3
v_mov_b32 v101, 79296
v_mov_b32 v158, 0
v_mov_b32 v159, 0
ds_write_b64 v101, v[158:159]
ds_write_b64 v101, v[158:159] offset:24
ds_write_b32 v101, v158 offset:32
s_waitcnt vmcnt(0)
ds_write_b128 v155, v[72:75]
s_mov_b32 exec_lo, 0xffff
s_mov_b32 exec_hi, 0x0
ds_write_b128 v155, v[76:79] offset:1024
s_mov_b64 exec, -1
s_waitcnt lgkmcnt(0)
s_barrier
s_mov_b32 s101, 0xfffffc00
s_add_u32 s94, s60, 1
s_and_b32 s60, s94, 0x3ff
s_add_u32 s61, s94, 341
s_and_b32 s61, s61, 0x3ff
s_add_u32 s62, s94, 682
s_and_b32 s62, s62, 0x3ff
s_add_u32 s63, s94, 1023
s_and_b32 s63, s63, 0x3ff
v_and_b32 v100, 3, v1
s_movk_i32 s64, 0x155
v_mul_u32_u24 v100, s64, v100
v_add_u32 v100, s94, v100
v_add_u32 v155, 65536, v15
v_add_u32 v156, s91, v15
s_barrier
ds_read2st64_b32 v[120:121], v155 offset0:0 offset1:1
ds_read2st64_b32 v[122:123], v155 offset0:2 offset1:3
ds_read2st64_b32 v[124:125], v155 offset0:4 offset1:5
ds_read2st64_b32 v[126:127], v155 offset0:6 offset1:7
ds_read2st64_b32 v[128:129], v155 offset0:8 offset1:9
ds_read2st64_b32 v[130:131], v155 offset0:10 offset1:11
ds_read2st64_b32 v[132:133], v155 offset0:12 offset1:13
ds_read2st64_b32 v[134:135], v155 offset0:14 offset1:15
ds_read2st64_b32 v[136:137], v155 offset0:16 offset1:17
s_waitcnt lgkmcnt(0)
v_pk_add_f32 v[120:121], v[120:121], v[122:123]
v_pk_add_f32 v[124:125], v[124:125], v[126:127]
v_pk_add_f32 v[128:129], v[128:129], v[130:131]
v_pk_add_f32 v[132:133], v[132:133], v[134:135]
v_pk_add_f32 v[120:121], v[120:121], v[124:125]
v_pk_add_f32 v[128:129], v[128:129], v[132:133]
v_pk_add_f32 v[120:121], v[120:121], v[128:129]
v_pk_add_f32 v[120:121], v[120:121], v[136:137]
v_add_f32 v120, v120, v121
v_bfi_b32 v120, v7, v100, v120
global_store_dword v156, v120, s[28:29] sc1
buffer_load_dwordx4 v[80:83], v4, s[56:59], 0 offen
buffer_load_dwordx4 v[84:87], v4, s[56:59], 0 offen offset:1024
s_barrier
s_waitcnt vmcnt(0)
v_mov_b32 v157, 0
s_mov_b32 s65, 0xffff0000
v_lshlrev_b32 v158, 16, v72
v_lshlrev_b32 v159, 16, v80
v_and_b32 v160, s65, v72
v_and_b32 v161, s65, v80
v_mul_f32 v158, v158, v159
v_mul_f32 v160, v160, v161
v_cvt_pk_bf16_f32 v158, v158, v160
v_lshlrev_b32 v159, 16, v158
v_and_b32 v158, s65, v158
v_add_f32 v157, v157, v159
v_add_f32 v157, v157, v158
v_lshlrev_b32 v158, 16, v73
v_lshlrev_b32 v159, 16, v81
v_and_b32 v160, s65, v73
v_and_b32 v161, s65, v81
v_mul_f32 v158, v158, v159
v_mul_f32 v160, v160, v161
v_cvt_pk_bf16_f32 v158, v158, v160
v_lshlrev_b32 v159, 16, v158
v_and_b32 v158, s65, v158
v_add_f32 v157, v157, v159
v_add_f32 v157, v157, v158
v_lshlrev_b32 v158, 16, v74
v_lshlrev_b32 v159, 16, v82
v_and_b32 v160, s65, v74
v_and_b32 v161, s65, v82
v_mul_f32 v158, v158, v159
v_mul_f32 v160, v160, v161
v_cvt_pk_bf16_f32 v158, v158, v160
v_lshlrev_b32 v159, 16, v158
v_and_b32 v158, s65, v158
v_add_f32 v157, v157, v159
v_add_f32 v157, v157, v158
v_lshlrev_b32 v158, 16, v75
v_lshlrev_b32 v159, 16, v83
v_and_b32 v160, s65, v75
v_and_b32 v161, s65, v83
v_mul_f32 v158, v158, v159
v_mul_f32 v160, v160, v161
v_cvt_pk_bf16_f32 v158, v158, v160
v_lshlrev_b32 v159, 16, v158
v_and_b32 v158, s65, v158
v_add_f32 v157, v157, v159
v_add_f32 v157, v157, v158
v_lshlrev_b32 v158, 16, v76
v_lshlrev_b32 v159, 16, v84
v_and_b32 v160, s65, v76
v_and_b32 v161, s65, v84
v_mul_f32 v158, v158, v159
v_mul_f32 v160, v160, v161
v_cvt_pk_bf16_f32 v158, v158, v160
v_lshlrev_b32 v159, 16, v158
v_and_b32 v158, s65, v158
v_add_f32 v157, v157, v159
v_add_f32 v157, v157, v158
v_lshlrev_b32 v158, 16, v77
v_lshlrev_b32 v159, 16, v85
v_and_b32 v160, s65, v77
v_and_b32 v161, s65, v85
v_mul_f32 v158, v158, v159
v_mul_f32 v160, v160, v161
v_cvt_pk_bf16_f32 v158, v158, v160
v_lshlrev_b32 v159, 16, v158
v_and_b32 v158, s65, v158
v_add_f32 v157, v157, v159
v_add_f32 v157, v157, v158
v_lshlrev_b32 v158, 16, v78
v_lshlrev_b32 v159, 16, v86
v_and_b32 v160, s65, v78
v_and_b32 v161, s65, v86
v_mul_f32 v158, v158, v159
v_mul_f32 v160, v160, v161
v_cvt_pk_bf16_f32 v158, v158, v160
v_lshlrev_b32 v159, 16, v158
v_and_b32 v158, s65, v158
v_add_f32 v157, v157, v159
v_add_f32 v157, v157, v158
v_lshlrev_b32 v158, 16, v79
v_lshlrev_b32 v159, 16, v87
v_and_b32 v160, s65, v79
v_and_b32 v161, s65, v87
v_mul_f32 v158, v158, v159
v_mul_f32 v160, v160, v161
v_cvt_pk_bf16_f32 v158, v158, v160
v_lshlrev_b32 v159, 16, v158
v_and_b32 v158, s65, v158
v_add_f32 v157, v157, v159
v_add_f32 v157, v157, v158
s_nop 1
v_add_f32_dpp v157, v157, v157 row_ror:8 row_mask:0xf bank_mask:0xf
s_nop 1
v_add_f32_dpp v157, v157, v157 row_ror:4 row_mask:0xf bank_mask:0xf
s_nop 1
v_add_f32_dpp v157, v157, v157 row_ror:2 row_mask:0xf bank_mask:0xf
s_nop 1
v_add_f32_dpp v157, v157, v157 row_ror:1 row_mask:0xf bank_mask:0xf
v_mov_b32 v158, v157
s_nop 1
v_permlane16_swap_b32 v157, v158
s_nop 0
v_add_f32 v157, v157, v158
v_mov_b32 v158, v157
s_nop 1
v_permlane32_swap_b32 v157, v158
s_nop 0
v_add_f32 v157, v157, v158
v_cvt_pk_bf16_f32 v157, v157, v157
v_and_b32 v157, s65, v157
v_mul_f32 v157, 0xbfb8aa3b, v157
v_exp_f32 v157, v157
s_nop 0
v_add_f32 v157, 1.0, v157
v_rcp_f32 v157, v157
s_nop 0
v_cvt_pk_bf16_f32 v157, v157, v157
v_and_b32 v158, s65, v157
v_sub_f32 v157, 1.0, v158
v_cvt_pk_bf16_f32 v157, v157, v157
v_and_b32 v159, s65, v157
ds_write_b64 v101, v[158:159] offset:16
v_mov_b32 v3, v158
v_add_u32 v155, 70144, v15
v_add_u32 v156, s30, v15
s_cmp_eq_u32 s95, 2
s_cbranch_scc1 L_nopub
s_barrier
ds_read2st64_b32 v[120:121], v155 offset0:0 offset1:1
ds_read2st64_b32 v[122:123], v155 offset0:2 offset1:3
ds_read2st64_b32 v[124:125], v155 offset0:4 offset1:5
ds_read2st64_b32 v[126:127], v155 offset0:6 offset1:7
ds_read2st64_b32 v[128:129], v155 offset0:8 offset1:9
ds_read2st64_b32 v[130:131], v155 offset0:10 offset1:11
ds_read2st64_b32 v[132:133], v155 offset0:12 offset1:13
ds_read2st64_b32 v[134:135], v155 offset0:14 offset1:15
ds_read2st64_b32 v[136:137], v155 offset0:16 offset1:17
ds_read2st64_b32 v[138:139], v155 offset0:18 offset1:19
ds_read2st64_b32 v[140:141], v155 offset0:20 offset1:21
ds_read2st64_b32 v[142:143], v155 offset0:22 offset1:23
ds_read2st64_b32 v[144:145], v155 offset0:24 offset1:25
ds_read2st64_b32 v[146:147], v155 offset0:26 offset1:27
ds_read2st64_b32 v[148:149], v155 offset0:28 offset1:29
ds_read2st64_b32 v[150:151], v155 offset0:30 offset1:31
global_load_dwordx4 v[104:107], v96, s[28:29] sc1
global_load_dwordx4 v[108:111], v97, s[28:29] sc1
global_load_dwordx4 v[112:115], v98, s[28:29] sc1
global_load_dwordx4 v[116:119], v99, s[28:29] sc1
s_waitcnt lgkmcnt(8)
v_pk_add_f32 v[120:121], v[120:121], v[122:123]
v_pk_add_f32 v[124:125], v[124:125], v[126:127]
v_pk_add_f32 v[128:129], v[128:129], v[130:131]
v_pk_add_f32 v[132:133], v[132:133], v[134:135]
v_pk_add_f32 v[120:121], v[120:121], v[124:125]
v_pk_add_f32 v[128:129], v[128:129], v[132:133]
v_pk_add_f32 v[120:121], v[120:121], v[128:129]
v_add_f32 v120, v120, v121
v_bfi_b32 v120, v7, v100, v120
global_store_dword v156, v120, s[28:29] sc1
v_add_u32 v156, 18432, v156
s_waitcnt lgkmcnt(0)
v_pk_add_f32 v[136:137], v[136:137], v[138:139]
v_pk_add_f32 v[140:141], v[140:141], v[142:143]
v_pk_add_f32 v[144:145], v[144:145], v[146:147]
v_pk_add_f32 v[148:149], v[148:149], v[150:151]
v_pk_add_f32 v[136:137], v[136:137], v[140:141]
v_pk_add_f32 v[144:145], v[144:145], v[148:149]
v_pk_add_f32 v[136:137], v[136:137], v[144:145]
v_add_f32 v136, v136, v137
v_bfi_b32 v136, v7, v100, v136
global_store_dword v156, v136, s[28:29] sc1
s_barrier
s_sleep 20
global_load_dwordx4 v[104:107], v96, s[28:29] sc1
global_load_dwordx4 v[108:111], v97, s[28:29] sc1
global_load_dwordx4 v[112:115], v98, s[28:29] sc1
global_load_dwordx4 v[116:119], v99, s[28:29] sc1
s_waitcnt vmcnt(6)
v_xor_b32 v157, s60, v104
v_bitop3_b32 v157, v105, s61, v157 bitop3:0xbe
v_bitop3_b32 v157, v106, s62, v157 bitop3:0xbe
v_bitop3_b32 v157, v107, s63, v157 bitop3:0xbe
v_bitop3_b32 v157, v108, s60, v157 bitop3:0xbe
v_bitop3_b32 v157, v109, s61, v157 bitop3:0xbe
v_bitop3_b32 v157, v110, s62, v157 bitop3:0xbe
v_bitop3_b32 v157, v111, s63, v157 bitop3:0xbe
v_bitop3_b32 v157, v112, s60, v157 bitop3:0xbe
v_bitop3_b32 v157, v113, s61, v157 bitop3:0xbe
v_bitop3_b32 v157, v114, s62, v157 bitop3:0xbe
v_bitop3_b32 v157, v115, s63, v157 bitop3:0xbe
v_bitop3_b32 v157, v116, s60, v157 bitop3:0xbe
v_bitop3_b32 v157, v117, s61, v157 bitop3:0xbe
v_bitop3_b32 v157, v118, s62, v157 bitop3:0xbe
v_bitop3_b32 v157, v119, s63, v157 bitop3:0xbe
v_and_b32 v157, v7, v157
v_cmp_ne_u32 vcc, 0, v157
s_cbranch_vccz L_qdone
s_branch L_pubd
L_nopub:
s_sleep 40
global_load_dwordx4 v[104:107], v96, s[28:29] sc1
global_load_dwordx4 v[108:111], v97, s[28:29] sc1
global_load_dwordx4 v[112:115], v98, s[28:29] sc1
global_load_dwordx4 v[116:119], v99, s[28:29] sc1
L_pubd:
s_movk_i32 s95, 20000
L_qchk:
s_waitcnt vmcnt(0)
v_xor_b32 v157, s60, v104
v_bitop3_b32 v157, v105, s61, v157 bitop3:0xbe
v_bitop3_b32 v157, v106, s62, v157 bitop3:0xbe
v_bitop3_b32 v157, v107, s63, v157 bitop3:0xbe
v_bitop3_b32 v157, v108, s60, v157 bitop3:0xbe
v_bitop3_b32 v157, v109, s61, v157 bitop3:0xbe
v_bitop3_b32 v157, v110, s62, v157 bitop3:0xbe
v_bitop3_b32 v157, v111, s63, v157 bitop3:0xbe
v_bitop3_b32 v157, v112, s60, v157 bitop3:0xbe
v_bitop3_b32 v157, v113, s61, v157 bitop3:0xbe
v_bitop3_b32 v157, v114, s62, v157 bitop3:0xbe
v_bitop3_b32 v157, v115, s63, v157 bitop3:0xbe
v_bitop3_b32 v157, v116, s60, v157 bitop3:0xbe
v_bitop3_b32 v157, v117, s61, v157 bitop3:0xbe
v_bitop3_b32 v157, v118, s62, v157 bitop3:0xbe
v_bitop3_b32 v157, v119, s63, v157 bitop3:0xbe
v_and_b32 v157, v7, v157
v_cmp_ne_u32 vcc, 0, v157
s_cbranch_vccz L_qdone
s_sleep 2
global_load_dwordx4 v[104:107], v96, s[28:29] sc1
global_load_dwordx4 v[108:111], v97, s[28:29] sc1
global_load_dwordx4 v[112:115], v98, s[28:29] sc1
global_load_dwordx4 v[116:119], v99, s[28:29] sc1
s_sub_u32 s95, s95, 1
s_cbranch_scc0 L_qchk
L_qdone:
v_and_b32 v120, s101, v104
v_and_b32 v121, s101, v105
v_and_b32 v122, s101, v106
v_and_b32 v123, s101, v107
v_and_b32 v124, s101, v108
v_and_b32 v125, s101, v109
v_and_b32 v126, s101, v110
v_and_b32 v127, s101, v111
v_and_b32 v128, s101, v112
v_and_b32 v129, s101, v113
v_and_b32 v130, s101, v114
v_and_b32 v131, s101, v115
v_and_b32 v132, s101, v116
v_and_b32 v133, s101, v117
v_and_b32 v134, s101, v118
v_and_b32 v135, s101, v119
v_pk_add_f32 v[120:121], v[120:121], v[124:125]
v_pk_add_f32 v[122:123], v[122:123], v[126:127]
v_pk_add_f32 v[128:129], v[128:129], v[132:133]
v_pk_add_f32 v[130:131], v[130:131], v[134:135]
v_pk_add_f32 v[120:121], v[120:121], v[128:129]
v_pk_add_f32 v[122:123], v[122:123], v[130:131]
v_cvt_pk_bf16_f32 v120, v120, v121
v_cvt_pk_bf16_f32 v121, v122, v123
v_mov_b32 v155, 78336
v_lshl_add_u32 v155, v1, 3, v155
ds_write_b64 v155, v[120:121]
s_waitcnt lgkmcnt(0)
s_barrier
s_mov_b32 exec_lo, 0xfff
s_mov_b32 exec_hi, 0x0
global_load_dword v28, v36, s[28:29] sc1
s_mov_b64 exec, -1
s_barrier
ds_read_b128 v[72:75], v39
ds_read_b128 v[76:79], v39 offset:16
s_mov_b32 s64, 0x3e0293ee
s_waitcnt lgkmcnt(0)
v_max3_f32 v160, v72, v73, v74
v_max3_f32 v160, v160, v75, v76
v_max3_f32 v160, v160, v77, v78
v_max_f32 v160, v160, v79
v_mul_f32 v160, s64, v160
v_bfi_b32 v164, v7, s60, v160
v_and_b32 v165, s101, v160
v_sub_f32 v165, v160, v165
v_bfi_b32 v165, v7, s61, v165
s_getreg_b32 s64, hwreg(HW_REG_XCC_ID, 0, 4)
s_lshl_b32 s64, s64, 10
s_or_b32 s68, s64, s63
v_mov_b32 v167, s68
v_mov_b32 v155, v15
s_waitcnt vmcnt(1)
L_lw:
ds_read_b32 v156, v101 offset:32
s_waitcnt lgkmcnt(0)
v_cmp_eq_u32 vcc, 8, v156
s_cbranch_vccz L_lw
ds_read_b128 v[72:75], v39 offset:64
ds_read_b128 v[76:79], v39 offset:80
s_waitcnt lgkmcnt(0)
v_pk_add_f32 v[72:73], v[72:73], v[74:75]
v_pk_add_f32 v[76:77], v[76:77], v[78:79]
v_pk_add_f32 v[72:73], v[72:73], v[76:77]
v_add_f32 v72, v72, v73
v_bfi_b32 v166, v7, s62, v72
s_mov_b32 s64, 1
s_mov_b32 s65, 1
L_ow:
ds_read_b32 v156, v101 offset:4
s_waitcnt lgkmcnt(0)
v_cmp_eq_u32 vcc, 8, v156
s_cbranch_vccz L_ow
ds_read_b128 v[104:107], v102 offset:0
ds_read_b128 v[108:111], v102 offset:1024
ds_read_b128 v[112:115], v102 offset:2048
ds_read_b128 v[116:119], v102 offset:3072
ds_read_b128 v[120:123], v102 offset:4096
ds_read_b128 v[124:127], v102 offset:5120
ds_read_b128 v[128:131], v102 offset:6144
ds_read_b128 v[132:135], v102 offset:7168
s_waitcnt lgkmcnt(6)
v_pk_add_f32 v[104:105], v[104:105], v[108:109]
v_pk_add_f32 v[106:107], v[106:107], v[110:111]
s_waitcnt lgkmcnt(4)
v_pk_add_f32 v[112:113], v[112:113], v[116:117]
v_pk_add_f32 v[114:115], v[114:115], v[118:119]
s_waitcnt lgkmcnt(2)
v_pk_add_f32 v[120:121], v[120:121], v[124:125]
v_pk_add_f32 v[122:123], v[122:123], v[126:127]
s_waitcnt lgkmcnt(0)
v_pk_add_f32 v[128:129], v[128:129], v[132:133]
v_pk_add_f32 v[130:131], v[130:131], v[134:135]
s_mov_b64 exec, s[64:65]
global_store_dwordx4 v20, v[164:167], s[28:29]
s_mov_b64 exec, -1
v_pk_add_f32 v[104:105], v[104:105], v[112:113]
v_pk_add_f32 v[106:107], v[106:107], v[114:115]
v_pk_add_f32 v[120:121], v[120:121], v[128:129]
v_pk_add_f32 v[122:123], v[122:123], v[130:131]
v_pk_add_f32 v[104:105], v[104:105], v[120:121]
v_pk_add_f32 v[106:107], v[106:107], v[122:123]
v_bfi_b32 v104, v7, s60, v104
v_bfi_b32 v105, v7, s61, v105
v_bfi_b32 v106, v7, s62, v106
v_bfi_b32 v107, v7, s63, v107
global_store_dwordx4 v19, v[104:107], s[28:29]
s_mov_b64 exec, -1
s_mov_b32 s95, 0
s_sleep 4
global_load_dwordx4 v[28:31], v37, s[28:29] sc1
s_sleep 3
global_load_dwordx4 v[28:31], v37, s[28:29] sc1
s_sleep 3
L_s1:
global_load_dwordx4 v[28:31], v37, s[28:29] sc1
s_add_u32 s95, s95, 1
s_waitcnt vmcnt(2)
v_xor_b32 v157, s60, v28
v_bitop3_b32 v157, v29, s61, v157 bitop3:0xbe
v_bitop3_b32 v157, v30, s62, v157 bitop3:0xbe
v_bitop3_b32 v157, v31, s63, v157 bitop3:0xbe
v_and_b32 v157, v7, v157
v_cmp_ne_u32 vcc, 0, v157
s_cbranch_vccz L_sd
s_cmp_lt_u32 s95, 48
s_cbranch_scc1 L_s1
s_mov_b32 exec_lo, 0x1
s_mov_b32 exec_hi, 0x1
global_store_dwordx4 v38, v[164:167], s[28:29] sc1
s_mov_b64 exec, -1
global_store_dwordx4 v14, v[104:107], s[28:29] sc1
L_s2:
s_waitcnt vmcnt(0)
s_add_u32 s95, s95, 1
global_load_dwordx4 v[28:31], v16, s[28:29] sc1
s_waitcnt vmcnt(0)
v_xor_b32 v157, s60, v28
v_bitop3_b32 v157, v29, s61, v157 bitop3:0xbe
v_bitop3_b32 v157, v30, s62, v157 bitop3:0xbe
v_bitop3_b32 v157, v31, s63, v157 bitop3:0xbe
v_and_b32 v157, v7, v157
v_cmp_ne_u32 vcc, 0, v157
s_cbranch_vccz L_sd
global_load_dwordx4 v[28:31], v37, s[28:29] sc1
s_waitcnt vmcnt(0)
v_xor_b32 v157, s60, v28
v_bitop3_b32 v157, v29, s61, v157 bitop3:0xbe
v_bitop3_b32 v157, v30, s62, v157 bitop3:0xbe
v_bitop3_b32 v157, v31, s63, v157 bitop3:0xbe
v_and_b32 v157, v7, v157
v_cmp_ne_u32 vcc, 0, v157
s_cbranch_vccz L_sd
s_cmp_lt_u32 s95, 20000
s_cbranch_scc1 L_s2
L_sd:
v_mov_b32 v156, 1
ds_write_b32 v101, v156 offset:28
v_and_b32 v44, s101, v28
v_and_b32 v45, s101, v29
v_add_f32 v41, v44, v45
v_add_f32 v40, v44, v45
v_and_b32 v46, s101, v30
v_max_f32_dpp v41, v41, v41 row_ror:8 row_mask:0xf bank_mask:0xf
s_nop 1
v_max_f32_dpp v41, v41, v41 row_ror:4 row_mask:0xf bank_mask:0xf
s_nop 1
v_max_f32_dpp v41, v41, v41 row_ror:2 row_mask:0xf bank_mask:0xf
s_nop 1
v_max_f32_dpp v41, v41, v41 row_ror:1 row_mask:0xf bank_mask:0xf
v_sub_f32 v40, v40, v41
v_exp_f32 v40, v40
s_nop 0
v_mul_f32 v42, v40, v46
v_mul_f32 v40, v3, v40
s_nop 0
v_add_f32_dpp v42, v42, v42 row_ror:8 row_mask:0xf bank_mask:0xf
s_nop 1
v_add_f32_dpp v42, v42, v42 row_ror:4 row_mask:0xf bank_mask:0xf
s_nop 1
v_add_f32_dpp v42, v42, v42 row_ror:2 row_mask:0xf bank_mask:0xf
s_nop 1
v_add_f32_dpp v42, v42, v42 row_ror:1 row_mask:0xf bank_mask:0xf
v_rcp_f32 v42, v42
v_mov_b32 v156, 1
v_mul_f32 v40, v40, v42
ds_write_b32 v103, v40
s_waitcnt lgkmcnt(0)
ds_write_b32 v101, v156 offset:24
v_cmp_ne_u32 vcc, s68, v31
s_cmp_gt_u32 s95, 48
s_cbranch_scc1 L_gd
s_cmp_ge_u32 s69, 5
s_cbranch_scc1 L_gn
s_nop 0
s_cbranch_vccz L_gd
L_gn:
s_sleep 4
s_mov_b32 exec_lo, 0x1
s_mov_b32 exec_hi, 0x1
global_store_dwordx4 v38, v[164:167], s[28:29] sc1
s_mov_b64 exec, -1
global_store_dwordx4 v14, v[104:107], s[28:29] sc1
s_movk_i32 s95, 49
L_gd:
s_barrier
ds_read2st64_b32 v[120:121], v155 offset0:0 offset1:1
ds_read2st64_b32 v[122:123], v155 offset0:2 offset1:3
ds_read2st64_b32 v[124:125], v155 offset0:4 offset1:5
ds_read2st64_b32 v[126:127], v155 offset0:6 offset1:7
ds_read2st64_b32 v[128:129], v155 offset0:8 offset1:9
ds_read2st64_b32 v[130:131], v155 offset0:10 offset1:11
ds_read2st64_b32 v[132:133], v155 offset0:12 offset1:13
ds_read2st64_b32 v[134:135], v155 offset0:14 offset1:15
s_cmp_lt_u32 s69, 5
s_cbranch_scc1 L_s16
ds_read2st64_b32 v[136:137], v155 offset0:16 offset1:17
ds_read2st64_b32 v[138:139], v155 offset0:18 offset1:19
ds_read2st64_b32 v[140:141], v155 offset0:20 offset1:21
s_waitcnt lgkmcnt(0)
v_pk_add_f32 v[136:137], v[136:137], v[138:139]
v_pk_add_f32 v[120:121], v[120:121], v[140:141]
v_pk_add_f32 v[122:123], v[122:123], v[136:137]
L_s16:
s_waitcnt lgkmcnt(0)
v_pk_add_f32 v[120:121], v[120:121], v[122:123]
v_pk_add_f32 v[124:125], v[124:125], v[126:127]
v_pk_add_f32 v[128:129], v[128:129], v[130:131]
v_pk_add_f32 v[132:133], v[132:133], v[134:135]
v_pk_add_f32 v[120:121], v[120:121], v[124:125]
v_pk_add_f32 v[128:129], v[128:129], v[132:133]
v_pk_add_f32 v[120:121], v[120:121], v[128:129]
v_add_f32 v120, v120, v121
v_bfi_b32 v120, v7, v100, v120
s_nop 1
v_mov_b32_dpp v121, v120 quad_perm:[1,1,1,1] row_mask:0xf bank_mask:0xf
v_mov_b32_dpp v122, v120 quad_perm:[2,2,2,2] row_mask:0xf bank_mask:0xf
v_mov_b32_dpp v123, v120 quad_perm:[3,3,3,3] row_mask:0xf bank_mask:0xf
s_mov_b32 exec_lo, 0x11111111
s_mov_b32 exec_hi, 0x11111111
global_store_dwordx4 v13, v[120:123], s[28:29] sc1
s_mov_b64 exec, -1
s_cmp_gt_u32 s95, 48
s_cbranch_scc1 L_fin
s_mov_b32 exec_lo, 0x1
s_mov_b32 exec_hi, 0x1
global_store_dwordx4 v38, v[164:167], s[28:29] sc1
s_mov_b64 exec, -1
global_store_dwordx4 v14, v[104:107], s[28:29] sc1
L_fin:
L_end:
s_endpgm
.section .rodata,"a"
.p2align 6
.amdhsa_kernel gated_mix__sliding_block_cached__glu_gated_reglu__decode_kernel
  .amdhsa_next_free_vgpr 168
  .amdhsa_next_free_sgpr 102
  .amdhsa_accum_offset 168
  .amdhsa_group_segment_fixed_size 0
  .amdhsa_kernarg_size 104
  .amdhsa_user_sgpr_count 2
  .amdhsa_user_sgpr_kernarg_segment_ptr 1
  .amdhsa_system_sgpr_workgroup_id_x 1
  .amdhsa_float_denorm_mode_32 3
  .amdhsa_float_denorm_mode_16_64 3
.end_amdhsa_kernel
```
